```python
import torch

def _softmax(x, axis=-1):
    return torch.softmax(x, dim=axis)
def _gelu(x):
    return torch.nn.functional.gelu(x, approximate="tanh")
def _silu(x):
    return torch.nn.functional.silu(x)
def _sigmoid(x):
    return torch.sigmoid(x)
def _layernorm(x, axis=-1, eps=1e-5):
    m = x.mean(dim=axis, keepdim=True)
    v = x.var(dim=axis, keepdim=True, unbiased=False)
    return (x - m) / torch.sqrt(v + eps)
def _scatter_add(tgt, idx, src, axis=0):
    return tgt.clone().index_add_(axis, idx, src)
def _segment_sum(src, seg, n):
    out = torch.zeros((n,) + src.shape[1:], dtype=src.dtype)
    return out.index_add_(0, seg, src)
def _pad(x, pw):
    flat = tuple(v for pair in reversed(pw) for v in pair)
    return torch.nn.functional.pad(x, flat)

kernel_name = 'standalone__gqa_block_cached__near_ridge'

def setup_inputs():

    _w = (lambda a: (lambda t: t.to(torch.bfloat16) if t.is_floating_point() else t)(torch.as_tensor(a)))
    B, Sq, D = 16, 96, 576
    Hq, Hkv, Sk, Dh = 32, 16, 512, 128
    assert Hq % Hkv == 0, (Hq, Hkv)
    return {
        "x": _w((lambda *s: torch.randn(*s, dtype=torch.bfloat16) * 0.8)(B, Sq, D)),
        "k_cache": _w((lambda *s: torch.randn(*s, dtype=torch.bfloat16) * 0.8)(B, Hkv, Sk, Dh)),
        "v_cache": _w((lambda *s: torch.randn(*s, dtype=torch.bfloat16) * 0.05)(B, Hkv, Sk, Dh)),
        "wq": _w((lambda *s: torch.randn(*s, dtype=torch.bfloat16) * 0.8)(D, Hq * Dh) * (D ** -0.5)),
        "wo": _w((lambda *s: torch.randn(*s, dtype=torch.bfloat16) * 0.05)(Hq * Dh, D) * ((Hq * Dh) ** -0.5)),
    }

def reference(x, k_cache, v_cache, wq, wo):
    B, Sq, D = x.shape
    Hq, Dh = 32, 128
    Hkv = k_cache.shape[1]
    rep = Hq // Hkv
    q = (lambda x, *d: x.permute(*d))((x @ wq).reshape(B, Sq, Hq, Dh), 0, 2, 1, 3)
    k = (lambda x, n, axis: torch.repeat_interleave(x, n, dim=axis))(k_cache, rep, axis=1)
    v = (lambda x, n, axis: torch.repeat_interleave(x, n, dim=axis))(v_cache, rep, axis=1)
    scores = torch.einsum("bhqd,bhkd->bhqk", q, k) * (Dh ** -0.5)
    p = _softmax(scores, axis=-1)
    o = torch.einsum("bhqk,bhkd->bhqd", p, v)
    return (lambda x, *d: x.permute(*d))(o, 0, 2, 1, 3).reshape(B, Sq, Hq * Dh) @ wo
```

```asm
; @launch grid=(256,1,1) block=(512,1,1) lds=163840
.amdgcn_target "amdgcn-amd-amdhsa--gfx950"
.text
.globl standalone__gqa_block_cached__near_ridge_kernel
.p2align 8
.type standalone__gqa_block_cached__near_ridge_kernel,@function
standalone__gqa_block_cached__near_ridge_kernel:
    s_cmp_ge_u32 s2, 256
    s_cbranch_scc1 L_end
    s_load_dwordx16 s[4:19], s[0:1], 0
    v_lshrrev_b32 v2, 6, v0
    v_and_b32 v0, 63, v0
    s_and_b32 s50, s2, 7
    s_lshr_b32 s51, s2, 3
    v_readfirstlane_b32 s20, v2
    s_and_b32 s52, s50, 3
    s_lshl_b32 s52, s52, 2
    s_and_b32 s53, s51, 3
    s_add_u32 s22, s52, s53
    s_lshr_b32 s52, s50, 2
    s_lshl_b32 s52, s52, 3
    s_lshr_b32 s53, s51, 2
    s_add_u32 s21, s52, s53
    s_lshl_b32 s23, s51, 1
    s_and_b32 s23, s23, 15
    s_lshl_b32 s54, s21, 4
    s_add_u32 s54, s54, s22
    s_mul_i32 s50, s21, 110592
    s_lshl_b32 s51, s54, 17
    s_lshl_b32 s52, s22, 9
    s_mul_i32 s53, s22, 294912
    s_mul_i32 s55, s54, 110592
    s_mov_b32 s26, 110592
    s_mov_b32 s27, 0x20000
    s_mov_b32 s30, 131072
    s_mov_b32 s31, 0x20000
    s_mov_b32 s34, 131072
    s_mov_b32 s35, 0x20000
    s_mov_b32 s38, 4710912
    s_mov_b32 s39, 0x20000
    s_mov_b32 s42, 294912
    s_mov_b32 s43, 0x20000
    s_mov_b32 s46, 110592
    s_mov_b32 s47, 0x20000
    s_waitcnt lgkmcnt(0)
    s_add_u32 s24, s4, s50
    s_addc_u32 s25, s5, 0
    s_add_u32 s28, s6, s51
    s_addc_u32 s29, s7, 0
    s_add_u32 s32, s8, s51
    s_addc_u32 s33, s9, 0
    s_add_u32 s36, s10, s52
    s_addc_u32 s37, s11, 0
    s_add_u32 s40, s12, s53
    s_addc_u32 s41, s13, 0
    s_add_u32 s44, s18, s55
    s_addc_u32 s45, s19, 0
    s_cmp_ge_u32 s20, 4
    s_cbranch_scc1 L_loaders
    v_and_b32 v10, 15, v0
    v_lshrrev_b32 v11, 4, v0
    v_bfe_u32 v12, v0, 2, 2
    v_and_b32 v13, 3, v0
    s_lshr_b32 s50, s20, 1
    s_and_b32 s51, s20, 1
    v_mul_u32_u24 v14, 4104, v11
    v_lshl_add_u32 v14, v12, 9, v14
    v_lshl_add_u32 v14, v13, 4, v14
    s_lshl_b32 s52, s50, 8
    s_add_u32 s52, s52, 90176
    v_add_u32 v14, s52, v14
    v_xor_b32 v15, 0, v12
    v_lshl_add_u32 v2, v15, 6, v14
    v_xor_b32 v15, 1, v12
    v_lshl_add_u32 v3, v15, 6, v14
    v_xor_b32 v15, 2, v12
    v_lshl_add_u32 v4, v15, 6, v14
    v_xor_b32 v15, 3, v12
    v_lshl_add_u32 v5, v15, 6, v14
    s_mul_i32 s52, s51, 6144
    s_add_u32 s52, s52, 123008
    v_lshlrev_b32 v14, 7, v10
    v_add_u32 v14, s52, v14
    v_lshrrev_b32 v15, 1, v10
    v_xor_b32 v15, v15, v11
    v_lshl_add_u32 v8, v15, 4, v14
    v_xor_b32 v9, 64, v8
    v_mov_b32 v6, v8
    v_mov_b32 v7, v9
    s_mov_b32 s49, -32832
    s_mov_b32 s50, 0
    s_mov_b32 s48, 9
    s_lshr_b32 s61, s20, 1
    s_mul_i32 s61, s61, 3072
    s_mul_i32 s60, s22, 6144
    s_add_u32 s60, s60, s61
    s_add_u32 s61, s61, 82944
    v_xor_b32 v14, v11, v10
    v_lshlrev_b32 v14, 4, v14
    v_lshl_add_u32 v200, v10, 8, v14
    v_xor_b32 v201, 64, v200
    v_xor_b32 v202, 128, v200
    v_xor_b32 v203, 192, v200
    v_lshl_add_u32 v14, v11, 2, v12
    v_lshlrev_b32 v15, 8, v14
    v_lshl_add_u32 v15, v13, 3, v15
    v_add_u32 v15, 8192, v15
    v_and_b32 v14, 7, v14
    v_lshl_add_u32 v204, v14, 5, v15
    s_mul_i32 s70, s20, 12288
    s_add_u32 s70, s70, 32768
    s_xor_b32 s71, s20, 2
    s_mul_i32 s71, s71, 12288
    s_add_u32 s71, s71, 32768
    s_mov_b32 s72, 0x3e0293ee
    v_bfe_u32 v14, v0, 3, 2
    s_and_b32 s52, s20, 2
    v_xor_b32 v14, s52, v14
    v_lshrrev_b32 v15, 2, v0
    v_lshlrev_b32 v14, 5, v14
    v_lshl_add_u32 v14, v15, 7, v14
    v_lshl_add_u32 v14, v13, 3, v14
    s_lshl_b32 s52, s52, 13
    s_add_u32 s52, s52, 131072
    v_add_u32 v205, s52, v14
    s_lshl_b32 s52, s51, 1
    s_lshr_b32 s53, s20, 1
    s_add_u32 s52, s52, s53
    s_mul_i32 s57, s52, 3072
    s_mov_b32 s58, 131072
    v_mov_b32 v16, 0
    v_mov_b32 v17, 0
    v_mov_b32 v18, 0
    v_mov_b32 v19, 0
    v_mov_b32 v20, 0
    v_mov_b32 v21, 0
    v_mov_b32 v22, 0
    v_mov_b32 v23, 0
    v_mov_b32 v24, 0
    v_mov_b32 v25, 0
    v_mov_b32 v26, 0
    v_mov_b32 v27, 0
    v_mov_b32 v28, 0
    v_mov_b32 v29, 0
    v_mov_b32 v30, 0
    v_mov_b32 v31, 0
    v_mov_b32 v32, 0
    v_mov_b32 v33, 0
    v_mov_b32 v34, 0
    v_mov_b32 v35, 0
    v_mov_b32 v36, 0
    v_mov_b32 v37, 0
    v_mov_b32 v38, 0
    v_mov_b32 v39, 0
    v_mov_b32 v40, 0
    v_mov_b32 v41, 0
    v_mov_b32 v42, 0
    v_mov_b32 v43, 0
    v_mov_b32 v44, 0
    v_mov_b32 v45, 0
    v_mov_b32 v46, 0
    v_mov_b32 v47, 0
    v_mov_b32 v48, 0
    v_mov_b32 v49, 0
    v_mov_b32 v50, 0
    v_mov_b32 v51, 0
    v_mov_b32 v52, 0
    v_mov_b32 v53, 0
    v_mov_b32 v54, 0
    v_mov_b32 v55, 0
    v_mov_b32 v56, 0
    v_mov_b32 v57, 0
    v_mov_b32 v58, 0
    v_mov_b32 v59, 0
    v_mov_b32 v60, 0
    v_mov_b32 v61, 0
    v_mov_b32 v62, 0
    v_mov_b32 v63, 0
    v_mov_b32 v64, 0
    v_mov_b32 v65, 0
    v_mov_b32 v66, 0
    v_mov_b32 v67, 0
    v_mov_b32 v68, 0
    v_mov_b32 v69, 0
    v_mov_b32 v70, 0
    v_mov_b32 v71, 0
    v_mov_b32 v72, 0
    v_mov_b32 v73, 0
    v_mov_b32 v74, 0
    v_mov_b32 v75, 0
    v_mov_b32 v76, 0
    v_mov_b32 v77, 0
    v_mov_b32 v78, 0
    v_mov_b32 v79, 0
    v_mov_b32 v80, 0
    v_mov_b32 v81, 0
    v_mov_b32 v82, 0
    v_mov_b32 v83, 0
    v_mov_b32 v84, 0
    v_mov_b32 v85, 0
    v_mov_b32 v86, 0
    v_mov_b32 v87, 0
    v_mov_b32 v88, 0
    v_mov_b32 v89, 0
    v_mov_b32 v90, 0
    v_mov_b32 v91, 0
    v_mov_b32 v92, 0
    v_mov_b32 v93, 0
    v_mov_b32 v94, 0
    v_mov_b32 v95, 0
    v_mov_b32 v96, 0
    v_mov_b32 v97, 0
    v_mov_b32 v98, 0
    v_mov_b32 v99, 0
    v_mov_b32 v100, 0
    v_mov_b32 v101, 0
    v_mov_b32 v102, 0
    v_mov_b32 v103, 0
    v_mov_b32 v104, 0
    v_mov_b32 v105, 0
    v_mov_b32 v106, 0
    v_mov_b32 v107, 0
    v_mov_b32 v108, 0
    v_mov_b32 v109, 0
    v_mov_b32 v110, 0
    v_mov_b32 v111, 0
    s_barrier
    ds_read_b128 v[144:147], v6 offset:0
    ds_read_b128 v[148:151], v6 offset:2048
    ds_read_b128 v[152:155], v6 offset:4096
    ds_read_b64_tr_b16 v[112:113], v2 offset:0
    ds_read_b64_tr_b16 v[114:115], v2 offset:2048
    ds_read_b64_tr_b16 v[116:117], v2 offset:8
    ds_read_b64_tr_b16 v[118:119], v2 offset:2056
    ds_read_b64_tr_b16 v[120:121], v3 offset:0
    ds_read_b64_tr_b16 v[122:123], v3 offset:2048
    ds_read_b64_tr_b16 v[124:125], v3 offset:8
    ds_read_b64_tr_b16 v[126:127], v3 offset:2056
    ds_read_b64_tr_b16 v[128:129], v4 offset:0
    ds_read_b64_tr_b16 v[130:131], v4 offset:2048
    ds_read_b64_tr_b16 v[132:133], v4 offset:8
    ds_read_b64_tr_b16 v[134:135], v4 offset:2056
    ds_read_b64_tr_b16 v[136:137], v5 offset:0
    ds_read_b64_tr_b16 v[138:139], v5 offset:2048
    ds_read_b64_tr_b16 v[140:141], v5 offset:8
    ds_read_b64_tr_b16 v[142:143], v5 offset:2056
L_q:
    s_waitcnt lgkmcnt(0)
    s_barrier
    v_mfma_f32_16x16x32_bf16 v[16:19], v[112:115], v[144:147], v[16:19]
    ds_read_b128 v[188:191], v7 offset:0
    v_mfma_f32_16x16x32_bf16 v[20:23], v[112:115], v[148:151], v[20:23]
    ds_read_b128 v[192:195], v7 offset:2048
    v_mfma_f32_16x16x32_bf16 v[24:27], v[112:115], v[152:155], v[24:27]
    ds_read_b128 v[196:199], v7 offset:4096
    v_mfma_f32_16x16x32_bf16 v[28:31], v[116:119], v[144:147], v[28:31]
    ds_read_b64_tr_b16 v[156:157], v2 offset:16416
    s_add_u32 s50, s50, 12288
    v_mfma_f32_16x16x32_bf16 v[32:35], v[116:119], v[148:151], v[32:35]
    ds_read_b64_tr_b16 v[158:159], v2 offset:18464
    s_cmp_eq_u32 s50, 36864
    v_mfma_f32_16x16x32_bf16 v[36:39], v[116:119], v[152:155], v[36:39]
    ds_read_b64_tr_b16 v[160:161], v2 offset:16424
    s_cselect_b32 s50, 0, s50
    v_mfma_f32_16x16x32_bf16 v[40:43], v[120:123], v[144:147], v[40:43]
    ds_read_b64_tr_b16 v[162:163], v2 offset:18472
    v_mfma_f32_16x16x32_bf16 v[44:47], v[120:123], v[148:151], v[44:47]
    ds_read_b64_tr_b16 v[164:165], v3 offset:16416
    v_mfma_f32_16x16x32_bf16 v[48:51], v[120:123], v[152:155], v[48:51]
    ds_read_b64_tr_b16 v[166:167], v3 offset:18464
    v_mfma_f32_16x16x32_bf16 v[52:55], v[124:127], v[144:147], v[52:55]
    ds_read_b64_tr_b16 v[168:169], v3 offset:16424
    v_mfma_f32_16x16x32_bf16 v[56:59], v[124:127], v[148:151], v[56:59]
    ds_read_b64_tr_b16 v[170:171], v3 offset:18472
    v_mfma_f32_16x16x32_bf16 v[60:63], v[124:127], v[152:155], v[60:63]
    ds_read_b64_tr_b16 v[172:173], v4 offset:16416
    v_mfma_f32_16x16x32_bf16 v[64:67], v[128:131], v[144:147], v[64:67]
    ds_read_b64_tr_b16 v[174:175], v4 offset:18464
    v_mfma_f32_16x16x32_bf16 v[68:71], v[128:131], v[148:151], v[68:71]
    ds_read_b64_tr_b16 v[176:177], v4 offset:16424
    v_mfma_f32_16x16x32_bf16 v[72:75], v[128:131], v[152:155], v[72:75]
    ds_read_b64_tr_b16 v[178:179], v4 offset:18472
    v_mfma_f32_16x16x32_bf16 v[76:79], v[132:135], v[144:147], v[76:79]
    ds_read_b64_tr_b16 v[180:181], v5 offset:16416
    v_mfma_f32_16x16x32_bf16 v[80:83], v[132:135], v[148:151], v[80:83]
    ds_read_b64_tr_b16 v[182:183], v5 offset:18464
    v_mfma_f32_16x16x32_bf16 v[84:87], v[132:135], v[152:155], v[84:87]
    ds_read_b64_tr_b16 v[184:185], v5 offset:16424
    v_mfma_f32_16x16x32_bf16 v[88:91], v[136:139], v[144:147], v[88:91]
    ds_read_b64_tr_b16 v[186:187], v5 offset:18472
    v_mfma_f32_16x16x32_bf16 v[92:95], v[136:139], v[148:151], v[92:95]
    v_add_u32 v2, s49, v2
    v_add_u32 v3, s49, v3
    v_mfma_f32_16x16x32_bf16 v[96:99], v[136:139], v[152:155], v[96:99]
    v_add_u32 v4, s49, v4
    v_add_u32 v5, s49, v5
    v_mfma_f32_16x16x32_bf16 v[100:103], v[140:143], v[144:147], v[100:103]
    v_add_u32 v6, s50, v8
    v_add_u32 v7, s50, v9
    v_mfma_f32_16x16x32_bf16 v[104:107], v[140:143], v[148:151], v[104:107]
    s_sub_u32 s49, 0, s49
    s_sub_u32 s48, s48, 1
    v_mfma_f32_16x16x32_bf16 v[108:111], v[140:143], v[152:155], v[108:111]
    s_cmp_eq_u32 s48, 0
    s_cbranch_scc1 L_q17
    s_waitcnt lgkmcnt(0)
    s_barrier
    v_mfma_f32_16x16x32_bf16 v[16:19], v[156:159], v[188:191], v[16:19]
    ds_read_b128 v[144:147], v6 offset:0
    v_mfma_f32_16x16x32_bf16 v[20:23], v[156:159], v[192:195], v[20:23]
    ds_read_b128 v[148:151], v6 offset:2048
    v_mfma_f32_16x16x32_bf16 v[24:27], v[156:159], v[196:199], v[24:27]
    ds_read_b128 v[152:155], v6 offset:4096
    v_mfma_f32_16x16x32_bf16 v[28:31], v[160:163], v[188:191], v[28:31]
    ds_read_b64_tr_b16 v[112:113], v2 offset:0
    v_mfma_f32_16x16x32_bf16 v[32:35], v[160:163], v[192:195], v[32:35]
    ds_read_b64_tr_b16 v[114:115], v2 offset:2048
    v_mfma_f32_16x16x32_bf16 v[36:39], v[160:163], v[196:199], v[36:39]
    ds_read_b64_tr_b16 v[116:117], v2 offset:8
    v_mfma_f32_16x16x32_bf16 v[40:43], v[164:167], v[188:191], v[40:43]
    ds_read_b64_tr_b16 v[118:119], v2 offset:2056
    v_mfma_f32_16x16x32_bf16 v[44:47], v[164:167], v[192:195], v[44:47]
    ds_read_b64_tr_b16 v[120:121], v3 offset:0
    v_mfma_f32_16x16x32_bf16 v[48:51], v[164:167], v[196:199], v[48:51]
    ds_read_b64_tr_b16 v[122:123], v3 offset:2048
    v_mfma_f32_16x16x32_bf16 v[52:55], v[168:171], v[188:191], v[52:55]
    ds_read_b64_tr_b16 v[124:125], v3 offset:8
    v_mfma_f32_16x16x32_bf16 v[56:59], v[168:171], v[192:195], v[56:59]
    ds_read_b64_tr_b16 v[126:127], v3 offset:2056
    v_mfma_f32_16x16x32_bf16 v[60:63], v[168:171], v[196:199], v[60:63]
    ds_read_b64_tr_b16 v[128:129], v4 offset:0
    v_mfma_f32_16x16x32_bf16 v[64:67], v[172:175], v[188:191], v[64:67]
    ds_read_b64_tr_b16 v[130:131], v4 offset:2048
    v_mfma_f32_16x16x32_bf16 v[68:71], v[172:175], v[192:195], v[68:71]
    ds_read_b64_tr_b16 v[132:133], v4 offset:8
    v_mfma_f32_16x16x32_bf16 v[72:75], v[172:175], v[196:199], v[72:75]
    ds_read_b64_tr_b16 v[134:135], v4 offset:2056
    v_mfma_f32_16x16x32_bf16 v[76:79], v[176:179], v[188:191], v[76:79]
    ds_read_b64_tr_b16 v[136:137], v5 offset:0
    v_mfma_f32_16x16x32_bf16 v[80:83], v[176:179], v[192:195], v[80:83]
    ds_read_b64_tr_b16 v[138:139], v5 offset:2048
    v_mfma_f32_16x16x32_bf16 v[84:87], v[176:179], v[196:199], v[84:87]
    ds_read_b64_tr_b16 v[140:141], v5 offset:8
    v_mfma_f32_16x16x32_bf16 v[88:91], v[180:183], v[188:191], v[88:91]
    ds_read_b64_tr_b16 v[142:143], v5 offset:2056
    v_mfma_f32_16x16x32_bf16 v[92:95], v[180:183], v[192:195], v[92:95]
    v_mfma_f32_16x16x32_bf16 v[96:99], v[180:183], v[196:199], v[96:99]
    v_mfma_f32_16x16x32_bf16 v[100:103], v[184:187], v[188:191], v[100:103]
    v_mfma_f32_16x16x32_bf16 v[104:107], v[184:187], v[192:195], v[104:107]
    v_mfma_f32_16x16x32_bf16 v[108:111], v[184:187], v[196:199], v[108:111]
    s_branch L_q
L_q17:
    s_waitcnt lgkmcnt(0)
    s_barrier
    v_mfma_f32_16x16x32_bf16 v[16:19], v[156:159], v[188:191], v[16:19]
    v_lshlrev_b32 v8, 4, v0
    v_mov_b32 v2, v205
    v_mfma_f32_16x16x32_bf16 v[20:23], v[156:159], v[192:195], v[20:23]
    v_add_u32 v6, s70, v8
    v_add_u32 v7, s71, v8
    v_mfma_f32_16x16x32_bf16 v[24:27], v[156:159], v[196:199], v[24:27]
    v_xor_b32 v3, 32, v205
    v_xor_b32 v4, 0x4000, v205
    v_mfma_f32_16x16x32_bf16 v[28:31], v[160:163], v[188:191], v[28:31]
    v_mul_f32 v16, s72, v16
    v_mul_f32 v17, s72, v17
    v_mfma_f32_16x16x32_bf16 v[32:35], v[160:163], v[192:195], v[32:35]
    v_mul_f32 v18, s72, v18
    v_mul_f32 v19, s72, v19
    v_mfma_f32_16x16x32_bf16 v[36:39], v[160:163], v[196:199], v[36:39]
    v_cvt_pk_bf16_f32 v208, v16, v17
    v_cvt_pk_bf16_f32 v209, v18, v19
    v_mfma_f32_16x16x32_bf16 v[40:43], v[164:167], v[188:191], v[40:43]
    ds_read_b128 v[16:19], v200 offset:0
    v_mul_f32 v20, s72, v20
    v_mfma_f32_16x16x32_bf16 v[44:47], v[164:167], v[192:195], v[44:47]
    v_mul_f32 v21, s72, v21
    v_mul_f32 v22, s72, v22
    v_mfma_f32_16x16x32_bf16 v[48:51], v[164:167], v[196:199], v[48:51]
    v_mul_f32 v23, s72, v23
    v_cvt_pk_bf16_f32 v212, v20, v21
    v_mfma_f32_16x16x32_bf16 v[52:55], v[168:171], v[188:191], v[52:55]
    v_cvt_pk_bf16_f32 v213, v22, v23
    ds_read_b128 v[20:23], v201 offset:0
    v_mfma_f32_16x16x32_bf16 v[56:59], v[168:171], v[192:195], v[56:59]
    v_mul_f32 v24, s72, v24
    v_mul_f32 v25, s72, v25
    v_mfma_f32_16x16x32_bf16 v[60:63], v[168:171], v[196:199], v[60:63]
    v_mul_f32 v26, s72, v26
    v_mul_f32 v27, s72, v27
    v_mfma_f32_16x16x32_bf16 v[64:67], v[172:175], v[188:191], v[64:67]
    v_cvt_pk_bf16_f32 v216, v24, v25
    v_cvt_pk_bf16_f32 v217, v26, v27
    v_mfma_f32_16x16x32_bf16 v[68:71], v[172:175], v[192:195], v[68:71]
    ds_read_b128 v[24:27], v202 offset:0
    v_mul_f32 v28, s72, v28
    v_mfma_f32_16x16x32_bf16 v[72:75], v[172:175], v[196:199], v[72:75]
    v_mul_f32 v29, s72, v29
    v_mul_f32 v30, s72, v30
    v_mfma_f32_16x16x32_bf16 v[76:79], v[176:179], v[188:191], v[76:79]
    v_mul_f32 v31, s72, v31
    v_cvt_pk_bf16_f32 v210, v28, v29
    v_mfma_f32_16x16x32_bf16 v[80:83], v[176:179], v[192:195], v[80:83]
    v_cvt_pk_bf16_f32 v211, v30, v31
    ds_read_b128 v[28:31], v203 offset:0
    v_mfma_f32_16x16x32_bf16 v[84:87], v[176:179], v[196:199], v[84:87]
    v_mul_f32 v32, s72, v32
    v_mul_f32 v33, s72, v33
    v_mfma_f32_16x16x32_bf16 v[88:91], v[180:183], v[188:191], v[88:91]
    v_mul_f32 v34, s72, v34
    v_mul_f32 v35, s72, v35
    v_mfma_f32_16x16x32_bf16 v[92:95], v[180:183], v[192:195], v[92:95]
    v_cvt_pk_bf16_f32 v214, v32, v33
    v_cvt_pk_bf16_f32 v215, v34, v35
    v_mfma_f32_16x16x32_bf16 v[96:99], v[180:183], v[196:199], v[96:99]
    ds_read_b128 v[32:35], v200 offset:4096
    v_mul_f32 v36, s72, v36
    v_mfma_f32_16x16x32_bf16 v[100:103], v[184:187], v[188:191], v[100:103]
    v_mul_f32 v37, s72, v37
    v_mul_f32 v38, s72, v38
    v_mfma_f32_16x16x32_bf16 v[104:107], v[184:187], v[192:195], v[104:107]
    v_mul_f32 v39, s72, v39
    v_cvt_pk_bf16_f32 v218, v36, v37
    v_mfma_f32_16x16x32_bf16 v[108:111], v[184:187], v[196:199], v[108:111]
    v_cvt_pk_bf16_f32 v219, v38, v39
    ds_read_b128 v[36:39], v201 offset:4096
    v_mul_f32 v48, s72, v48
    v_mul_f32 v49, s72, v49
    v_mul_f32 v50, s72, v50
    v_mul_f32 v51, s72, v51
    v_cvt_pk_bf16_f32 v228, v48, v49
    v_cvt_pk_bf16_f32 v229, v50, v51
    s_waitcnt lgkmcnt(4)
    v_mfma_f32_16x16x32_bf16 v[48:51], v[16:19], v[208:211], 0
    v_mul_f32 v52, s72, v52
    v_mul_f32 v53, s72, v53
    v_mul_f32 v54, s72, v54
    v_mul_f32 v55, s72, v55
    v_cvt_pk_bf16_f32 v222, v52, v53
    v_cvt_pk_bf16_f32 v223, v54, v55
    v_mfma_f32_16x16x32_bf16 v[52:55], v[16:19], v[212:215], 0
    v_mul_f32 v56, s72, v56
    v_mul_f32 v57, s72, v57
    v_mul_f32 v58, s72, v58
    v_mul_f32 v59, s72, v59
    v_cvt_pk_bf16_f32 v226, v56, v57
    v_cvt_pk_bf16_f32 v227, v58, v59
    v_mfma_f32_16x16x32_bf16 v[56:59], v[16:19], v[216:219], 0
    v_mul_f32 v40, s72, v40
    v_mul_f32 v41, s72, v41
    v_mul_f32 v42, s72, v42
    v_mul_f32 v43, s72, v43
    v_cvt_pk_bf16_f32 v220, v40, v41
    v_cvt_pk_bf16_f32 v221, v42, v43
    ds_read_b128 v[40:43], v202 offset:4096
    v_mul_f32 v44, s72, v44
    v_mul_f32 v45, s72, v45
    v_mul_f32 v46, s72, v46
    v_mul_f32 v47, s72, v47
    v_cvt_pk_bf16_f32 v224, v44, v45
    v_cvt_pk_bf16_f32 v225, v46, v47
    ds_read_b128 v[44:47], v203 offset:4096
    v_mfma_f32_16x16x32_bf16 v[48:51], v[20:23], v[220:223], v[48:51]
    v_mul_f32 v60, s72, v60
    v_mul_f32 v61, s72, v61
    v_mul_f32 v62, s72, v62
    v_mul_f32 v63, s72, v63
    v_cvt_pk_bf16_f32 v230, v60, v61
    v_cvt_pk_bf16_f32 v231, v62, v63
    v_mfma_f32_16x16x32_bf16 v[52:55], v[20:23], v[224:227], v[52:55]
    v_mul_f32 v72, s72, v72
    v_mul_f32 v73, s72, v73
    v_mul_f32 v74, s72, v74
    v_mul_f32 v75, s72, v75
    v_cvt_pk_bf16_f32 v240, v72, v73
    v_cvt_pk_bf16_f32 v241, v74, v75
    v_mfma_f32_16x16x32_bf16 v[56:59], v[20:23], v[228:231], v[56:59]
    v_mul_f32 v76, s72, v76
    v_mul_f32 v77, s72, v77
    v_mul_f32 v78, s72, v78
    s_waitcnt lgkmcnt(2)
    v_mfma_f32_16x16x32_bf16 v[72:75], v[32:35], v[208:211], 0
    v_mul_f32 v79, s72, v79
    v_cvt_pk_bf16_f32 v234, v76, v77
    v_cvt_pk_bf16_f32 v235, v78, v79
    v_mul_f32 v80, s72, v80
    v_mul_f32 v81, s72, v81
    v_mfma_f32_16x16x32_bf16 v[76:79], v[32:35], v[212:215], 0
    v_mul_f32 v82, s72, v82
    v_mul_f32 v83, s72, v83
    v_cvt_pk_bf16_f32 v238, v80, v81
    v_mfma_f32_16x16x32_bf16 v[72:75], v[36:39], v[220:223], v[72:75]
    v_cvt_pk_bf16_f32 v239, v82, v83
    v_mul_f32 v64, s72, v64
    v_mul_f32 v65, s72, v65
    v_mfma_f32_16x16x32_bf16 v[80:83], v[32:35], v[216:219], 0
    v_mul_f32 v66, s72, v66
    v_mul_f32 v67, s72, v67
    v_cvt_pk_bf16_f32 v232, v64, v65
    v_mfma_f32_16x16x32_bf16 v[76:79], v[36:39], v[224:227], v[76:79]
    v_cvt_pk_bf16_f32 v233, v66, v67
    v_mul_f32 v68, s72, v68
    v_mul_f32 v69, s72, v69
    v_mfma_f32_16x16x32_bf16 v[80:83], v[36:39], v[228:231], v[80:83]
    v_mul_f32 v70, s72, v70
    v_mul_f32 v71, s72, v71
    v_cvt_pk_bf16_f32 v236, v68, v69
    v_mfma_f32_16x16x32_bf16 v[48:51], v[24:27], v[232:235], v[48:51]
    v_cvt_pk_bf16_f32 v237, v70, v71
    v_mul_f32 v84, s72, v84
    v_mul_f32 v85, s72, v85
    v_mfma_f32_16x16x32_bf16 v[52:55], v[24:27], v[236:239], v[52:55]
    v_mul_f32 v86, s72, v86
    v_mul_f32 v87, s72, v87
    v_cvt_pk_bf16_f32 v242, v84, v85
    v_cvt_pk_bf16_f32 v243, v86, v87
    v_mul_f32 v88, s72, v88
    v_mul_f32 v89, s72, v89
    v_mfma_f32_16x16x32_bf16 v[56:59], v[24:27], v[240:243], v[56:59]
    v_mul_f32 v90, s72, v90
    v_mul_f32 v91, s72, v91
    v_cvt_pk_bf16_f32 v244, v88, v89
    v_cvt_pk_bf16_f32 v245, v90, v91
    v_mul_f32 v100, s72, v100
    v_mul_f32 v101, s72, v101
    v_mul_f32 v102, s72, v102
    v_mul_f32 v103, s72, v103
    v_cvt_pk_bf16_f32 v246, v100, v101
    v_cvt_pk_bf16_f32 v247, v102, v103
    v_mul_f32 v92, s72, v92
    v_mul_f32 v93, s72, v93
    v_mfma_f32_16x16x32_bf16 v[48:51], v[28:31], v[244:247], v[48:51]
    v_mul_f32 v94, s72, v94
    v_mul_f32 v95, s72, v95
    v_cvt_pk_bf16_f32 v248, v92, v93
    v_cvt_pk_bf16_f32 v249, v94, v95
    v_mul_f32 v104, s72, v104
    v_mul_f32 v105, s72, v105
    v_mul_f32 v106, s72, v106
    v_mul_f32 v107, s72, v107
    v_cvt_pk_bf16_f32 v250, v104, v105
    v_cvt_pk_bf16_f32 v251, v106, v107
    v_mul_f32 v96, s72, v96
    v_mul_f32 v97, s72, v97
    v_mfma_f32_16x16x32_bf16 v[52:55], v[28:31], v[248:251], v[52:55]
    v_mul_f32 v98, s72, v98
    v_mul_f32 v99, s72, v99
    v_cvt_pk_bf16_f32 v252, v96, v97
    v_cvt_pk_bf16_f32 v253, v98, v99
    v_mul_f32 v108, s72, v108
    v_mul_f32 v109, s72, v109
    v_mul_f32 v110, s72, v110
    v_mul_f32 v111, s72, v111
    v_cvt_pk_bf16_f32 v254, v108, v109
    v_cvt_pk_bf16_f32 v255, v110, v111
    v_mov_b32 v100, v200
    v_mov_b32 v101, v201
    s_waitcnt lgkmcnt(0)
    v_mfma_f32_16x16x32_bf16 v[56:59], v[28:31], v[252:255], v[56:59]
    v_exp_f32 v48, v48
    v_mfma_f32_16x16x32_bf16 v[72:75], v[40:43], v[232:235], v[72:75]
    v_exp_f32 v49, v49
    v_mfma_f32_16x16x32_bf16 v[76:79], v[40:43], v[236:239], v[76:79]
    v_cvt_pk_bf16_f32 v48, v48, v49
    v_exp_f32 v50, v50
    v_mfma_f32_16x16x32_bf16 v[80:83], v[40:43], v[240:243], v[80:83]
    v_exp_f32 v51, v51
    v_mfma_f32_16x16x32_bf16 v[72:75], v[44:47], v[244:247], v[72:75]
    v_cvt_pk_bf16_f32 v49, v50, v51
    v_exp_f32 v52, v52
    v_mfma_f32_16x16x32_bf16 v[76:79], v[44:47], v[248:251], v[76:79]
    v_exp_f32 v53, v53
    v_mfma_f32_16x16x32_bf16 v[80:83], v[44:47], v[252:255], v[80:83]
    v_cvt_pk_bf16_f32 v52, v52, v53
    v_mov_b32 v102, v202
    v_mov_b32 v103, v203
    s_barrier
    ds_read_b128 v[16:19], v100 offset:16384
    ds_read_b128 v[20:23], v101 offset:16384
    ds_read_b128 v[24:27], v102 offset:16384
    ds_read_b128 v[28:31], v103 offset:16384
    ds_read_b128 v[32:35], v100 offset:20480
    ds_read_b128 v[36:39], v101 offset:20480
    ds_read_b128 v[40:43], v102 offset:20480
    ds_read_b128 v[44:47], v103 offset:20480
    v_exp_f32 v54, v54
    v_exp_f32 v55, v55
    v_xor_b32 v104, 0, v204
    v_cvt_pk_bf16_f32 v53, v54, v55
    v_exp_f32 v56, v56
    v_exp_f32 v57, v57
    v_xor_b32 v105, 32, v204
    v_cvt_pk_bf16_f32 v56, v56, v57
    v_exp_f32 v58, v58
    v_exp_f32 v59, v59
    v_xor_b32 v106, 64, v204
    v_cvt_pk_bf16_f32 v57, v58, v59
    v_exp_f32 v72, v72
    v_exp_f32 v73, v73
    v_xor_b32 v107, 96, v204
    v_cvt_pk_bf16_f32 v50, v72, v73
    v_exp_f32 v74, v74
    v_exp_f32 v75, v75
    v_xor_b32 v108, 128, v204
    v_cvt_pk_bf16_f32 v51, v74, v75
    v_exp_f32 v76, v76
    v_exp_f32 v77, v77
    v_xor_b32 v109, 160, v204
    v_cvt_pk_bf16_f32 v54, v76, v77
    v_exp_f32 v78, v78
    v_exp_f32 v79, v79
    v_xor_b32 v110, 192, v204
    v_cvt_pk_bf16_f32 v55, v78, v79
    v_xor_b32 v111, 224, v204
    v_mov_b32 v96, 0x3f803f80
    v_mov_b32 v97, 0x3f803f80
    v_mov_b32 v98, 0x3f803f80
    v_mov_b32 v99, 0x3f803f80
    v_xor_b32 v5, 0x4020, v205
    v_add_u32 v9, s61, v8
    s_mov_b32 s49, 32768
    s_mov_b32 s48, 8
    s_waitcnt lgkmcnt(4)
    v_mfma_f32_16x16x32_bf16 v[60:63], v[16:19], v[208:211], 0
    v_exp_f32 v80, v80
    v_mfma_f32_16x16x32_bf16 v[64:67], v[16:19], v[212:215], 0
    v_exp_f32 v81, v81
    v_mfma_f32_16x16x32_bf16 v[68:71], v[16:19], v[216:219], 0
    ds_read_b64_tr_b16 v[16:17], v104 offset:0
    v_cvt_pk_bf16_f32 v58, v80, v81
    v_mfma_f32_16x16x32_bf16 v[60:63], v[20:23], v[220:223], v[60:63]
    ds_read_b64_tr_b16 v[18:19], v104 offset:4096
    v_mfma_f32_16x16x32_bf16 v[64:67], v[20:23], v[224:227], v[64:67]
    v_exp_f32 v82, v82
    v_mfma_f32_16x16x32_bf16 v[68:71], v[20:23], v[228:231], v[68:71]
    ds_read_b64_tr_b16 v[20:21], v105 offset:0
    v_mfma_f32_16x16x32_bf16 v[60:63], v[24:27], v[232:235], v[60:63]
    ds_read_b64_tr_b16 v[22:23], v105 offset:4096
    v_mfma_f32_16x16x32_bf16 v[64:67], v[24:27], v[236:239], v[64:67]
    v_exp_f32 v83, v83
    v_mfma_f32_16x16x32_bf16 v[68:71], v[24:27], v[240:243], v[68:71]
    ds_read_b64_tr_b16 v[24:25], v106 offset:0
    v_cvt_pk_bf16_f32 v59, v82, v83
    v_mfma_f32_16x16x32_bf16 v[60:63], v[28:31], v[244:247], v[60:63]
    ds_read_b64_tr_b16 v[26:27], v106 offset:4096
    v_mfma_f32_16x16x32_bf16 v[64:67], v[28:31], v[248:251], v[64:67]
    v_xor_b32 v100, s49, v100
    v_xor_b32 v101, s49, v101
    v_mfma_f32_16x16x32_bf16 v[68:71], v[28:31], v[252:255], v[68:71]
    ds_read_b64_tr_b16 v[28:29], v107 offset:0
    s_waitcnt lgkmcnt(7)
    v_mfma_f32_16x16x32_bf16 v[72:75], v[32:35], v[208:211], 0
    ds_read_b64_tr_b16 v[30:31], v107 offset:4096
    v_mfma_f32_16x16x32_bf16 v[76:79], v[32:35], v[212:215], 0
    v_xor_b32 v102, s49, v102
    v_xor_b32 v103, s49, v103
    v_mfma_f32_16x16x32_bf16 v[80:83], v[32:35], v[216:219], 0
    ds_read_b64_tr_b16 v[32:33], v108 offset:0
    v_mfma_f32_16x16x32_bf16 v[72:75], v[36:39], v[220:223], v[72:75]
    ds_read_b64_tr_b16 v[34:35], v108 offset:4096
    v_mfma_f32_16x16x32_bf16 v[76:79], v[36:39], v[224:227], v[76:79]
    v_exp_f32 v60, v60
    v_mfma_f32_16x16x32_bf16 v[80:83], v[36:39], v[228:231], v[80:83]
    ds_read_b64_tr_b16 v[36:37], v109 offset:0
    s_sub_u32 s48, s48, 1
    v_mfma_f32_16x16x32_bf16 v[72:75], v[40:43], v[232:235], v[72:75]
    ds_read_b64_tr_b16 v[38:39], v109 offset:4096
    v_mfma_f32_16x16x32_bf16 v[76:79], v[40:43], v[236:239], v[76:79]
    v_exp_f32 v61, v61
    v_mfma_f32_16x16x32_bf16 v[80:83], v[40:43], v[240:243], v[80:83]
    ds_read_b64_tr_b16 v[40:41], v110 offset:0
    v_cvt_pk_bf16_f32 v60, v60, v61
    v_mfma_f32_16x16x32_bf16 v[72:75], v[44:47], v[244:247], v[72:75]
    ds_read_b64_tr_b16 v[42:43], v110 offset:4096
    v_mfma_f32_16x16x32_bf16 v[76:79], v[44:47], v[248:251], v[76:79]
    v_exp_f32 v62, v62
    v_mfma_f32_16x16x32_bf16 v[80:83], v[44:47], v[252:255], v[80:83]
    ds_read_b64_tr_b16 v[44:45], v111 offset:0
    s_waitcnt lgkmcnt(7)
    s_barrier
    v_mfma_f32_16x16x32_bf16 v[112:115], v[16:19], v[48:51], 0
    ds_read_b64_tr_b16 v[46:47], v111 offset:4096
    v_mfma_f32_16x16x32_bf16 v[116:119], v[16:19], v[52:55], 0
    v_exp_f32 v63, v63
    v_mfma_f32_16x16x32_bf16 v[120:123], v[16:19], v[56:59], 0
    ds_read_b128 v[16:19], v100 offset:0
    v_cvt_pk_bf16_f32 v61, v62, v63
    v_mfma_f32_16x16x32_bf16 v[124:127], v[20:23], v[48:51], 0
    v_exp_f32 v64, v64
    v_mfma_f32_16x16x32_bf16 v[128:131], v[20:23], v[52:55], 0
    v_exp_f32 v65, v65
    v_mfma_f32_16x16x32_bf16 v[132:135], v[20:23], v[56:59], 0
    ds_read_b128 v[20:23], v101 offset:0
    v_cvt_pk_bf16_f32 v64, v64, v65
    v_mfma_f32_16x16x32_bf16 v[136:139], v[24:27], v[48:51], 0
    v_exp_f32 v66, v66
    v_mfma_f32_16x16x32_bf16 v[140:143], v[24:27], v[52:55], 0
    v_exp_f32 v67, v67
    v_mfma_f32_16x16x32_bf16 v[144:147], v[24:27], v[56:59], 0
    ds_read_b128 v[24:27], v102 offset:0
    v_cvt_pk_bf16_f32 v65, v66, v67
    v_mfma_f32_16x16x32_bf16 v[148:151], v[28:31], v[48:51], 0
    v_exp_f32 v68, v68
    v_mfma_f32_16x16x32_bf16 v[152:155], v[28:31], v[52:55], 0
    v_exp_f32 v69, v69
    v_mfma_f32_16x16x32_bf16 v[156:159], v[28:31], v[56:59], 0
    ds_read_b128 v[28:31], v103 offset:0
    v_cvt_pk_bf16_f32 v68, v68, v69
    s_waitcnt lgkmcnt(4)
    v_mfma_f32_16x16x32_bf16 v[160:163], v[32:35], v[48:51], 0
    v_exp_f32 v70, v70
    v_mfma_f32_16x16x32_bf16 v[164:167], v[32:35], v[52:55], 0
    v_exp_f32 v71, v71
    v_mfma_f32_16x16x32_bf16 v[168:171], v[32:35], v[56:59], 0
    ds_read_b128 v[32:35], v100 offset:4096
    v_cvt_pk_bf16_f32 v69, v70, v71
    v_mfma_f32_16x16x32_bf16 v[172:175], v[36:39], v[48:51], 0
    v_exp_f32 v72, v72
    v_mfma_f32_16x16x32_bf16 v[176:179], v[36:39], v[52:55], 0
    v_exp_f32 v73, v73
    v_mfma_f32_16x16x32_bf16 v[180:183], v[36:39], v[56:59], 0
    ds_read_b128 v[36:39], v101 offset:4096
    v_cvt_pk_bf16_f32 v62, v72, v73
    v_mfma_f32_16x16x32_bf16 v[184:187], v[40:43], v[48:51], 0
    v_exp_f32 v74, v74
    v_mfma_f32_16x16x32_bf16 v[188:191], v[40:43], v[52:55], 0
    v_exp_f32 v75, v75
    v_mfma_f32_16x16x32_bf16 v[192:195], v[40:43], v[56:59], 0
    ds_read_b128 v[40:43], v102 offset:4096
    v_cvt_pk_bf16_f32 v63, v74, v75
    v_mfma_f32_16x16x32_bf16 v[196:199], v[44:47], v[48:51], 0
    v_exp_f32 v76, v76
    v_mfma_f32_16x16x32_bf16 v[200:203], v[44:47], v[52:55], 0
    v_exp_f32 v77, v77
    v_mfma_f32_16x16x32_bf16 v[204:207], v[44:47], v[56:59], 0
    ds_read_b128 v[44:47], v103 offset:4096
    v_cvt_pk_bf16_f32 v66, v76, v77
    v_mfma_f32_16x16x32_bf16 v[84:87], v[96:99], v[48:51], 0
    v_exp_f32 v78, v78
    v_mfma_f32_16x16x32_bf16 v[88:91], v[96:99], v[52:55], 0
    v_exp_f32 v79, v79
    v_mfma_f32_16x16x32_bf16 v[92:95], v[96:99], v[56:59], 0
    v_cvt_pk_bf16_f32 v67, v78, v79
    s_cmp_eq_u32 s48, 0
    s_branch L_a2
    s_endpgm
    s_endpgm
    s_endpgm
    s_endpgm
    s_endpgm
    s_endpgm
L_a:
    s_waitcnt lgkmcnt(4)
    v_mfma_f32_16x16x32_bf16 v[60:63], v[16:19], v[208:211], 0
    v_exp_f32 v80, v80
    v_mfma_f32_16x16x32_bf16 v[64:67], v[16:19], v[212:215], 0
    v_exp_f32 v81, v81
    v_mfma_f32_16x16x32_bf16 v[68:71], v[16:19], v[216:219], 0
    ds_read_b64_tr_b16 v[16:17], v104 offset:0
    v_cvt_pk_bf16_f32 v58, v80, v81
    v_mfma_f32_16x16x32_bf16 v[60:63], v[20:23], v[220:223], v[60:63]
    ds_read_b64_tr_b16 v[18:19], v104 offset:4096
    v_mfma_f32_16x16x32_bf16 v[64:67], v[20:23], v[224:227], v[64:67]
    v_exp_f32 v82, v82
    v_mfma_f32_16x16x32_bf16 v[68:71], v[20:23], v[228:231], v[68:71]
    ds_read_b64_tr_b16 v[20:21], v105 offset:0
    v_mfma_f32_16x16x32_bf16 v[60:63], v[24:27], v[232:235], v[60:63]
    ds_read_b64_tr_b16 v[22:23], v105 offset:4096
    v_mfma_f32_16x16x32_bf16 v[64:67], v[24:27], v[236:239], v[64:67]
    v_exp_f32 v83, v83
    v_mfma_f32_16x16x32_bf16 v[68:71], v[24:27], v[240:243], v[68:71]
    ds_read_b64_tr_b16 v[24:25], v106 offset:0
    v_cvt_pk_bf16_f32 v59, v82, v83
    v_mfma_f32_16x16x32_bf16 v[60:63], v[28:31], v[244:247], v[60:63]
    ds_read_b64_tr_b16 v[26:27], v106 offset:4096
    v_mfma_f32_16x16x32_bf16 v[64:67], v[28:31], v[248:251], v[64:67]
    v_xor_b32 v100, s49, v100
    v_xor_b32 v101, s49, v101
    v_mfma_f32_16x16x32_bf16 v[68:71], v[28:31], v[252:255], v[68:71]
    ds_read_b64_tr_b16 v[28:29], v107 offset:0
    s_waitcnt lgkmcnt(7)
    v_mfma_f32_16x16x32_bf16 v[72:75], v[32:35], v[208:211], 0
    ds_read_b64_tr_b16 v[30:31], v107 offset:4096
    v_mfma_f32_16x16x32_bf16 v[76:79], v[32:35], v[212:215], 0
    v_xor_b32 v102, s49, v102
    v_xor_b32 v103, s49, v103
    v_mfma_f32_16x16x32_bf16 v[80:83], v[32:35], v[216:219], 0
    ds_read_b64_tr_b16 v[32:33], v108 offset:0
    v_mfma_f32_16x16x32_bf16 v[72:75], v[36:39], v[220:223], v[72:75]
    ds_read_b64_tr_b16 v[34:35], v108 offset:4096
    v_mfma_f32_16x16x32_bf16 v[76:79], v[36:39], v[224:227], v[76:79]
    v_exp_f32 v60, v60
    v_mfma_f32_16x16x32_bf16 v[80:83], v[36:39], v[228:231], v[80:83]
    ds_read_b64_tr_b16 v[36:37], v109 offset:0
    s_sub_u32 s48, s48, 1
    v_mfma_f32_16x16x32_bf16 v[72:75], v[40:43], v[232:235], v[72:75]
    ds_read_b64_tr_b16 v[38:39], v109 offset:4096
    v_mfma_f32_16x16x32_bf16 v[76:79], v[40:43], v[236:239], v[76:79]
    v_exp_f32 v61, v61
    v_mfma_f32_16x16x32_bf16 v[80:83], v[40:43], v[240:243], v[80:83]
    ds_read_b64_tr_b16 v[40:41], v110 offset:0
    v_cvt_pk_bf16_f32 v60, v60, v61
    v_mfma_f32_16x16x32_bf16 v[72:75], v[44:47], v[244:247], v[72:75]
    ds_read_b64_tr_b16 v[42:43], v110 offset:4096
    v_mfma_f32_16x16x32_bf16 v[76:79], v[44:47], v[248:251], v[76:79]
    v_exp_f32 v62, v62
    v_mfma_f32_16x16x32_bf16 v[80:83], v[44:47], v[252:255], v[80:83]
    ds_read_b64_tr_b16 v[44:45], v111 offset:0
    s_waitcnt lgkmcnt(7)
    s_barrier
    v_mfma_f32_16x16x32_bf16 v[112:115], v[16:19], v[48:51], v[112:115]
    ds_read_b64_tr_b16 v[46:47], v111 offset:4096
    v_mfma_f32_16x16x32_bf16 v[116:119], v[16:19], v[52:55], v[116:119]
    v_exp_f32 v63, v63
    v_mfma_f32_16x16x32_bf16 v[120:123], v[16:19], v[56:59], v[120:123]
    ds_read_b128 v[16:19], v100 offset:0
    v_cvt_pk_bf16_f32 v61, v62, v63
    v_mfma_f32_16x16x32_bf16 v[124:127], v[20:23], v[48:51], v[124:127]
    v_exp_f32 v64, v64
    v_mfma_f32_16x16x32_bf16 v[128:131], v[20:23], v[52:55], v[128:131]
    v_exp_f32 v65, v65
    v_mfma_f32_16x16x32_bf16 v[132:135], v[20:23], v[56:59], v[132:135]
    ds_read_b128 v[20:23], v101 offset:0
    v_cvt_pk_bf16_f32 v64, v64, v65
    v_mfma_f32_16x16x32_bf16 v[136:139], v[24:27], v[48:51], v[136:139]
    v_exp_f32 v66, v66
    v_mfma_f32_16x16x32_bf16 v[140:143], v[24:27], v[52:55], v[140:143]
    v_exp_f32 v67, v67
    v_mfma_f32_16x16x32_bf16 v[144:147], v[24:27], v[56:59], v[144:147]
    ds_read_b128 v[24:27], v102 offset:0
    v_cvt_pk_bf16_f32 v65, v66, v67
    v_mfma_f32_16x16x32_bf16 v[148:151], v[28:31], v[48:51], v[148:151]
    v_exp_f32 v68, v68
    v_mfma_f32_16x16x32_bf16 v[152:155], v[28:31], v[52:55], v[152:155]
    v_exp_f32 v69, v69
    v_mfma_f32_16x16x32_bf16 v[156:159], v[28:31], v[56:59], v[156:159]
    ds_read_b128 v[28:31], v103 offset:0
    v_cvt_pk_bf16_f32 v68, v68, v69
    s_waitcnt lgkmcnt(4)
    v_mfma_f32_16x16x32_bf16 v[160:163], v[32:35], v[48:51], v[160:163]
    v_exp_f32 v70, v70
    v_mfma_f32_16x16x32_bf16 v[164:167], v[32:35], v[52:55], v[164:167]
    v_exp_f32 v71, v71
    v_mfma_f32_16x16x32_bf16 v[168:171], v[32:35], v[56:59], v[168:171]
    ds_read_b128 v[32:35], v100 offset:4096
    v_cvt_pk_bf16_f32 v69, v70, v71
    v_mfma_f32_16x16x32_bf16 v[172:175], v[36:39], v[48:51], v[172:175]
    v_exp_f32 v72, v72
    v_mfma_f32_16x16x32_bf16 v[176:179], v[36:39], v[52:55], v[176:179]
    v_exp_f32 v73, v73
    v_mfma_f32_16x16x32_bf16 v[180:183], v[36:39], v[56:59], v[180:183]
    ds_read_b128 v[36:39], v101 offset:4096
    v_cvt_pk_bf16_f32 v62, v72, v73
    v_mfma_f32_16x16x32_bf16 v[184:187], v[40:43], v[48:51], v[184:187]
    v_exp_f32 v74, v74
    v_mfma_f32_16x16x32_bf16 v[188:191], v[40:43], v[52:55], v[188:191]
    v_exp_f32 v75, v75
    v_mfma_f32_16x16x32_bf16 v[192:195], v[40:43], v[56:59], v[192:195]
    ds_read_b128 v[40:43], v102 offset:4096
    v_cvt_pk_bf16_f32 v63, v74, v75
    v_mfma_f32_16x16x32_bf16 v[196:199], v[44:47], v[48:51], v[196:199]
    v_exp_f32 v76, v76
    v_mfma_f32_16x16x32_bf16 v[200:203], v[44:47], v[52:55], v[200:203]
    v_exp_f32 v77, v77
    v_mfma_f32_16x16x32_bf16 v[204:207], v[44:47], v[56:59], v[204:207]
    ds_read_b128 v[44:47], v103 offset:4096
    v_cvt_pk_bf16_f32 v66, v76, v77
    v_mfma_f32_16x16x32_bf16 v[84:87], v[96:99], v[48:51], v[84:87]
    v_exp_f32 v78, v78
    v_mfma_f32_16x16x32_bf16 v[88:91], v[96:99], v[52:55], v[88:91]
    v_exp_f32 v79, v79
    v_mfma_f32_16x16x32_bf16 v[92:95], v[96:99], v[56:59], v[92:95]
    v_cvt_pk_bf16_f32 v67, v78, v79
    s_cmp_eq_u32 s48, 0
    s_cbranch_scc1 L_ae
L_a2:
    s_waitcnt lgkmcnt(4)
    v_mfma_f32_16x16x32_bf16 v[48:51], v[16:19], v[208:211], 0
    v_exp_f32 v80, v80
    v_mfma_f32_16x16x32_bf16 v[52:55], v[16:19], v[212:215], 0
    v_exp_f32 v81, v81
    v_mfma_f32_16x16x32_bf16 v[56:59], v[16:19], v[216:219], 0
    ds_read_b64_tr_b16 v[16:17], v104 offset:16384
    v_cvt_pk_bf16_f32 v70, v80, v81
    v_mfma_f32_16x16x32_bf16 v[48:51], v[20:23], v[220:223], v[48:51]
    ds_read_b64_tr_b16 v[18:19], v104 offset:20480
    v_mfma_f32_16x16x32_bf16 v[52:55], v[20:23], v[224:227], v[52:55]
    v_exp_f32 v82, v82
    v_mfma_f32_16x16x32_bf16 v[56:59], v[20:23], v[228:231], v[56:59]
    ds_read_b64_tr_b16 v[20:21], v105 offset:16384
    v_mfma_f32_16x16x32_bf16 v[48:51], v[24:27], v[232:235], v[48:51]
    ds_read_b64_tr_b16 v[22:23], v105 offset:20480
    v_mfma_f32_16x16x32_bf16 v[52:55], v[24:27], v[236:239], v[52:55]
    v_exp_f32 v83, v83
    v_mfma_f32_16x16x32_bf16 v[56:59], v[24:27], v[240:243], v[56:59]
    ds_read_b64_tr_b16 v[24:25], v106 offset:16384
    v_cvt_pk_bf16_f32 v71, v82, v83
    v_mfma_f32_16x16x32_bf16 v[48:51], v[28:31], v[244:247], v[48:51]
    ds_read_b64_tr_b16 v[26:27], v106 offset:20480
    v_mfma_f32_16x16x32_bf16 v[52:55], v[28:31], v[248:251], v[52:55]
    v_xor_b32 v104, s49, v104
    v_xor_b32 v105, s49, v105
    v_mfma_f32_16x16x32_bf16 v[56:59], v[28:31], v[252:255], v[56:59]
    ds_read_b64_tr_b16 v[28:29], v107 offset:16384
    s_waitcnt lgkmcnt(7)
    v_mfma_f32_16x16x32_bf16 v[72:75], v[32:35], v[208:211], 0
    ds_read_b64_tr_b16 v[30:31], v107 offset:20480
    v_mfma_f32_16x16x32_bf16 v[76:79], v[32:35], v[212:215], 0
    v_xor_b32 v106, s49, v106
    v_xor_b32 v107, s49, v107
    v_mfma_f32_16x16x32_bf16 v[80:83], v[32:35], v[216:219], 0
    ds_read_b64_tr_b16 v[32:33], v108 offset:16384
    v_mfma_f32_16x16x32_bf16 v[72:75], v[36:39], v[220:223], v[72:75]
    ds_read_b64_tr_b16 v[34:35], v108 offset:20480
    v_mfma_f32_16x16x32_bf16 v[76:79], v[36:39], v[224:227], v[76:79]
    v_exp_f32 v48, v48
    v_mfma_f32_16x16x32_bf16 v[80:83], v[36:39], v[228:231], v[80:83]
    ds_read_b64_tr_b16 v[36:37], v109 offset:16384
    v_xor_b32 v108, s49, v108
    v_mfma_f32_16x16x32_bf16 v[72:75], v[40:43], v[232:235], v[72:75]
    ds_read_b64_tr_b16 v[38:39], v109 offset:20480
    v_mfma_f32_16x16x32_bf16 v[76:79], v[40:43], v[236:239], v[76:79]
    v_exp_f32 v49, v49
    v_mfma_f32_16x16x32_bf16 v[80:83], v[40:43], v[240:243], v[80:83]
    ds_read_b64_tr_b16 v[40:41], v110 offset:16384
    v_cvt_pk_bf16_f32 v48, v48, v49
    v_mfma_f32_16x16x32_bf16 v[72:75], v[44:47], v[244:247], v[72:75]
    ds_read_b64_tr_b16 v[42:43], v110 offset:20480
    v_xor_b32 v109, s49, v109
    v_mfma_f32_16x16x32_bf16 v[76:79], v[44:47], v[248:251], v[76:79]
    v_exp_f32 v50, v50
    v_mfma_f32_16x16x32_bf16 v[80:83], v[44:47], v[252:255], v[80:83]
    ds_read_b64_tr_b16 v[44:45], v111 offset:16384
    v_xor_b32 v110, s49, v110
    s_waitcnt lgkmcnt(7)
    s_barrier
    v_mfma_f32_16x16x32_bf16 v[112:115], v[16:19], v[60:63], v[112:115]
    ds_read_b64_tr_b16 v[46:47], v111 offset:20480
    v_mfma_f32_16x16x32_bf16 v[116:119], v[16:19], v[64:67], v[116:119]
    v_exp_f32 v51, v51
    v_mfma_f32_16x16x32_bf16 v[120:123], v[16:19], v[68:71], v[120:123]
    ds_read_b128 v[16:19], v100 offset:16384
    v_cvt_pk_bf16_f32 v49, v50, v51
    v_mfma_f32_16x16x32_bf16 v[124:127], v[20:23], v[60:63], v[124:127]
    v_exp_f32 v52, v52
    v_mfma_f32_16x16x32_bf16 v[128:131], v[20:23], v[64:67], v[128:131]
    v_exp_f32 v53, v53
    v_mfma_f32_16x16x32_bf16 v[132:135], v[20:23], v[68:71], v[132:135]
    ds_read_b128 v[20:23], v101 offset:16384
    v_cvt_pk_bf16_f32 v52, v52, v53
    v_mfma_f32_16x16x32_bf16 v[136:139], v[24:27], v[60:63], v[136:139]
    v_exp_f32 v54, v54
    v_mfma_f32_16x16x32_bf16 v[140:143], v[24:27], v[64:67], v[140:143]
    v_exp_f32 v55, v55
    v_mfma_f32_16x16x32_bf16 v[144:147], v[24:27], v[68:71], v[144:147]
    ds_read_b128 v[24:27], v102 offset:16384
    v_cvt_pk_bf16_f32 v53, v54, v55
    v_mfma_f32_16x16x32_bf16 v[148:151], v[28:31], v[60:63], v[148:151]
    v_exp_f32 v56, v56
    v_mfma_f32_16x16x32_bf16 v[152:155], v[28:31], v[64:67], v[152:155]
    v_exp_f32 v57, v57
    v_mfma_f32_16x16x32_bf16 v[156:159], v[28:31], v[68:71], v[156:159]
    ds_read_b128 v[28:31], v103 offset:16384
    v_cvt_pk_bf16_f32 v56, v56, v57
    s_waitcnt lgkmcnt(4)
    v_mfma_f32_16x16x32_bf16 v[160:163], v[32:35], v[60:63], v[160:163]
    v_exp_f32 v58, v58
    v_mfma_f32_16x16x32_bf16 v[164:167], v[32:35], v[64:67], v[164:167]
    v_exp_f32 v59, v59
    v_mfma_f32_16x16x32_bf16 v[168:171], v[32:35], v[68:71], v[168:171]
    ds_read_b128 v[32:35], v100 offset:20480
    v_cvt_pk_bf16_f32 v57, v58, v59
    v_mfma_f32_16x16x32_bf16 v[172:175], v[36:39], v[60:63], v[172:175]
    v_exp_f32 v72, v72
    v_mfma_f32_16x16x32_bf16 v[176:179], v[36:39], v[64:67], v[176:179]
    v_exp_f32 v73, v73
    v_mfma_f32_16x16x32_bf16 v[180:183], v[36:39], v[68:71], v[180:183]
    ds_read_b128 v[36:39], v101 offset:20480
    v_cvt_pk_bf16_f32 v50, v72, v73
    v_mfma_f32_16x16x32_bf16 v[184:187], v[40:43], v[60:63], v[184:187]
    v_exp_f32 v74, v74
    v_mfma_f32_16x16x32_bf16 v[188:191], v[40:43], v[64:67], v[188:191]
    v_exp_f32 v75, v75
    v_mfma_f32_16x16x32_bf16 v[192:195], v[40:43], v[68:71], v[192:195]
    ds_read_b128 v[40:43], v102 offset:20480
    v_cvt_pk_bf16_f32 v51, v74, v75
    v_mfma_f32_16x16x32_bf16 v[196:199], v[44:47], v[60:63], v[196:199]
    v_exp_f32 v76, v76
    v_mfma_f32_16x16x32_bf16 v[200:203], v[44:47], v[64:67], v[200:203]
    v_exp_f32 v77, v77
    v_mfma_f32_16x16x32_bf16 v[204:207], v[44:47], v[68:71], v[204:207]
    ds_read_b128 v[44:47], v103 offset:20480
    v_cvt_pk_bf16_f32 v54, v76, v77
    v_mfma_f32_16x16x32_bf16 v[84:87], v[96:99], v[60:63], v[84:87]
    v_exp_f32 v78, v78
    v_mfma_f32_16x16x32_bf16 v[88:91], v[96:99], v[64:67], v[88:91]
    v_exp_f32 v79, v79
    v_mfma_f32_16x16x32_bf16 v[92:95], v[96:99], v[68:71], v[92:95]
    v_cvt_pk_bf16_f32 v55, v78, v79
    v_xor_b32 v111, s49, v111
    s_xor_b32 s49, s49, 65536
    s_branch L_a
L_ae:
    s_waitcnt lgkmcnt(0)
    ds_read_b64_tr_b16 v[16:17], v104 offset:16384
    ds_read_b64_tr_b16 v[18:19], v104 offset:20480
    ds_read_b64_tr_b16 v[20:21], v105 offset:16384
    ds_read_b64_tr_b16 v[22:23], v105 offset:20480
    ds_read_b64_tr_b16 v[24:25], v106 offset:16384
    ds_read_b64_tr_b16 v[26:27], v106 offset:20480
    ds_read_b64_tr_b16 v[28:29], v107 offset:16384
    ds_read_b64_tr_b16 v[30:31], v107 offset:20480
    ds_read_b64_tr_b16 v[32:33], v108 offset:16384
    ds_read_b64_tr_b16 v[34:35], v108 offset:20480
    ds_read_b64_tr_b16 v[36:37], v109 offset:16384
    ds_read_b64_tr_b16 v[38:39], v109 offset:20480
    ds_read_b64_tr_b16 v[40:41], v110 offset:16384
    ds_read_b64_tr_b16 v[42:43], v110 offset:20480
    ds_read_b64_tr_b16 v[44:45], v111 offset:16384
    ds_read_b64_tr_b16 v[46:47], v111 offset:20480
    v_exp_f32 v80, v80
    v_exp_f32 v81, v81
    s_nop 0
    v_cvt_pk_bf16_f32 v70, v80, v81
    v_exp_f32 v82, v82
    v_exp_f32 v83, v83
    s_nop 0
    v_cvt_pk_bf16_f32 v71, v82, v83
    s_nop 1
    v_mfma_f32_16x16x32_bf16 v[84:87], v[96:99], v[60:63], v[84:87]
    v_mfma_f32_16x16x32_bf16 v[88:91], v[96:99], v[64:67], v[88:91]
    v_mfma_f32_16x16x32_bf16 v[92:95], v[96:99], v[68:71], v[92:95]
    s_waitcnt lgkmcnt(12)
    s_nop 0
    v_mfma_f32_16x16x32_bf16 v[112:115], v[16:19], v[60:63], v[112:115]
    s_mov_b32 s48, 4
    v_mfma_f32_16x16x32_bf16 v[116:119], v[16:19], v[64:67], v[116:119]
    v_mfma_f32_16x16x32_bf16 v[120:123], v[16:19], v[68:71], v[120:123]
    v_mfma_f32_16x16x32_bf16 v[124:127], v[20:23], v[60:63], v[124:127]
    v_mfma_f32_16x16x32_bf16 v[128:131], v[20:23], v[64:67], v[128:131]
    s_nop 1
    v_mfma_f32_16x16x32_bf16 v[132:135], v[20:23], v[68:71], v[132:135]
    v_min3_f32 v100, v84, v88, v92
    v_max3_f32 v101, v84, v88, v92
    v_cmp_gt_f32 vcc, 0x2b800000, v100
    s_mov_b64 s[50:51], vcc
    v_cmp_lt_f32 vcc, 0x53800000, v101
    s_or_b64 vcc, vcc, s[50:51]
    s_cbranch_scc1 L_slow
L_norm:
    v_rcp_f32 v84, v84
    v_rcp_f32 v88, v88
    v_rcp_f32 v92, v92
    s_waitcnt lgkmcnt(8)
    v_mfma_f32_16x16x32_bf16 v[136:139], v[24:27], v[60:63], v[136:139]
    ds_read_b64_tr_b16 v[48:49], v2 offset:0
    v_mul_f32 v112, v84, v112
    v_mul_f32 v113, v84, v113
    v_mul_f32 v114, v84, v114
    v_mul_f32 v115, v84, v115
    v_cvt_pk_bf16_f32 v208, v112, v113
    v_cvt_pk_bf16_f32 v209, v114, v115
    v_mfma_f32_16x16x32_bf16 v[140:143], v[24:27], v[64:67], v[140:143]
    ds_read_b64_tr_b16 v[50:51], v2 offset:2048
    v_mul_f32 v116, v88, v116
    v_mul_f32 v117, v88, v117
    v_mul_f32 v118, v88, v118
    v_mul_f32 v119, v88, v119
    v_cvt_pk_bf16_f32 v212, v116, v117
    v_cvt_pk_bf16_f32 v213, v118, v119
    v_mul_f32 v120, v92, v120
    v_mfma_f32_16x16x32_bf16 v[144:147], v[24:27], v[68:71], v[144:147]
    ds_read_b64_tr_b16 v[52:53], v3 offset:0
    v_mul_f32 v121, v92, v121
    v_mul_f32 v122, v92, v122
    v_mul_f32 v123, v92, v123
    v_cvt_pk_bf16_f32 v216, v120, v121
    v_cvt_pk_bf16_f32 v217, v122, v123
    v_mul_f32 v124, v84, v124
    v_mfma_f32_16x16x32_bf16 v[148:151], v[28:31], v[60:63], v[148:151]
    ds_read_b64_tr_b16 v[54:55], v3 offset:2048
    v_mul_f32 v125, v84, v125
    v_mul_f32 v126, v84, v126
    v_mul_f32 v127, v84, v127
    v_cvt_pk_bf16_f32 v210, v124, v125
    v_cvt_pk_bf16_f32 v211, v126, v127
    ds_write_b128 v6, v[208:211] offset:0
    v_mul_f32 v128, v88, v128
    v_mfma_f32_16x16x32_bf16 v[152:155], v[28:31], v[64:67], v[152:155]
    v_mul_f32 v129, v88, v129
    v_mul_f32 v130, v88, v130
    v_mul_f32 v131, v88, v131
    v_cvt_pk_bf16_f32 v214, v128, v129
    v_cvt_pk_bf16_f32 v215, v130, v131
    ds_write_b128 v6, v[212:215] offset:1024
    v_mfma_f32_16x16x32_bf16 v[156:159], v[28:31], v[68:71], v[156:159]
    v_mul_f32 v132, v92, v132
    v_mul_f32 v133, v92, v133
    v_mul_f32 v134, v92, v134
    v_mul_f32 v135, v92, v135
    v_cvt_pk_bf16_f32 v218, v132, v133
    v_cvt_pk_bf16_f32 v219, v134, v135
    ds_write_b128 v6, v[216:219] offset:2048
    s_waitcnt lgkmcnt(11)
    v_mfma_f32_16x16x32_bf16 v[160:163], v[32:35], v[60:63], v[160:163]
    ds_read_b64_tr_b16 v[72:73], v2 offset:4096
    v_mul_f32 v136, v84, v136
    v_mul_f32 v137, v84, v137
    v_mul_f32 v138, v84, v138
    v_mul_f32 v139, v84, v139
    v_cvt_pk_bf16_f32 v220, v136, v137
    v_cvt_pk_bf16_f32 v221, v138, v139
    v_mfma_f32_16x16x32_bf16 v[164:167], v[32:35], v[64:67], v[164:167]
    ds_read_b64_tr_b16 v[74:75], v2 offset:6144
    v_mul_f32 v140, v88, v140
    v_mul_f32 v141, v88, v141
    v_mul_f32 v142, v88, v142
    v_mul_f32 v143, v88, v143
    v_cvt_pk_bf16_f32 v224, v140, v141
    v_cvt_pk_bf16_f32 v225, v142, v143
    v_mul_f32 v144, v92, v144
    v_mfma_f32_16x16x32_bf16 v[168:171], v[32:35], v[68:71], v[168:171]
    ds_read_b64_tr_b16 v[76:77], v3 offset:4096
    v_mul_f32 v145, v92, v145
    v_mul_f32 v146, v92, v146
    v_mul_f32 v147, v92, v147
    v_cvt_pk_bf16_f32 v228, v144, v145
    v_cvt_pk_bf16_f32 v229, v146, v147
    v_mul_f32 v148, v84, v148
    v_mfma_f32_16x16x32_bf16 v[172:175], v[36:39], v[60:63], v[172:175]
    ds_read_b64_tr_b16 v[78:79], v3 offset:6144
    v_mul_f32 v149, v84, v149
    v_mul_f32 v150, v84, v150
    v_mul_f32 v151, v84, v151
    v_cvt_pk_bf16_f32 v222, v148, v149
    v_cvt_pk_bf16_f32 v223, v150, v151
    ds_write_b128 v6, v[220:223] offset:3072
    v_mul_f32 v152, v88, v152
    v_mfma_f32_16x16x32_bf16 v[176:179], v[36:39], v[64:67], v[176:179]
    v_mul_f32 v153, v88, v153
    v_mul_f32 v154, v88, v154
    v_mul_f32 v155, v88, v155
    v_cvt_pk_bf16_f32 v226, v152, v153
    v_cvt_pk_bf16_f32 v227, v154, v155
    ds_write_b128 v6, v[224:227] offset:4096
    v_mfma_f32_16x16x32_bf16 v[180:183], v[36:39], v[68:71], v[180:183]
    v_mul_f32 v156, v92, v156
    v_mul_f32 v157, v92, v157
    v_mul_f32 v158, v92, v158
    v_mul_f32 v159, v92, v159
    v_cvt_pk_bf16_f32 v230, v156, v157
    v_cvt_pk_bf16_f32 v231, v158, v159
    ds_write_b128 v6, v[228:231] offset:5120
    s_waitcnt lgkmcnt(14)
    v_mfma_f32_16x16x32_bf16 v[184:187], v[40:43], v[60:63], v[184:187]
    ds_read_b64_tr_b16 v[96:97], v2 offset:8192
    v_mul_f32 v160, v84, v160
    v_mul_f32 v161, v84, v161
    v_mul_f32 v162, v84, v162
    v_mul_f32 v163, v84, v163
    v_cvt_pk_bf16_f32 v232, v160, v161
    v_cvt_pk_bf16_f32 v233, v162, v163
    v_mfma_f32_16x16x32_bf16 v[188:191], v[40:43], v[64:67], v[188:191]
    ds_read_b64_tr_b16 v[98:99], v2 offset:10240
    v_mul_f32 v164, v88, v164
    v_mul_f32 v165, v88, v165
    v_mul_f32 v166, v88, v166
    v_mul_f32 v167, v88, v167
    v_cvt_pk_bf16_f32 v236, v164, v165
    v_cvt_pk_bf16_f32 v237, v166, v167
    v_mul_f32 v168, v92, v168
    v_mfma_f32_16x16x32_bf16 v[192:195], v[40:43], v[68:71], v[192:195]
    ds_read_b64_tr_b16 v[100:101], v3 offset:8192
    v_mul_f32 v169, v92, v169
    v_mul_f32 v170, v92, v170
    v_mul_f32 v171, v92, v171
    v_cvt_pk_bf16_f32 v240, v168, v169
    v_cvt_pk_bf16_f32 v241, v170, v171
    v_mul_f32 v172, v84, v172
    v_mfma_f32_16x16x32_bf16 v[196:199], v[44:47], v[60:63], v[196:199]
    ds_read_b64_tr_b16 v[102:103], v3 offset:10240
    v_mul_f32 v173, v84, v173
    v_mul_f32 v174, v84, v174
    v_mul_f32 v175, v84, v175
    v_cvt_pk_bf16_f32 v234, v172, v173
    v_cvt_pk_bf16_f32 v235, v174, v175
    ds_write_b128 v6, v[232:235] offset:6144
    v_mul_f32 v176, v88, v176
    v_mfma_f32_16x16x32_bf16 v[200:203], v[44:47], v[64:67], v[200:203]
    v_mul_f32 v177, v88, v177
    v_mul_f32 v178, v88, v178
    v_mul_f32 v179, v88, v179
    v_cvt_pk_bf16_f32 v238, v176, v177
    v_cvt_pk_bf16_f32 v239, v178, v179
    ds_write_b128 v6, v[236:239] offset:7168
    v_mfma_f32_16x16x32_bf16 v[204:207], v[44:47], v[68:71], v[204:207]
    v_mul_f32 v180, v92, v180
    v_mul_f32 v181, v92, v181
    v_mul_f32 v182, v92, v182
    v_mul_f32 v183, v92, v183
    v_cvt_pk_bf16_f32 v242, v180, v181
    v_cvt_pk_bf16_f32 v243, v182, v183
    ds_write_b128 v6, v[240:243] offset:8192
    s_waitcnt lgkmcnt(14)
    v_mfma_f32_16x16x32_bf16 v[112:115], v[48:51], v[208:211], 0
    ds_read_b64_tr_b16 v[104:105], v2 offset:12288
    v_mul_f32 v184, v84, v184
    v_mul_f32 v185, v84, v185
    v_mul_f32 v186, v84, v186
    v_mul_f32 v187, v84, v187
    v_cvt_pk_bf16_f32 v244, v184, v185
    v_cvt_pk_bf16_f32 v245, v186, v187
    v_mfma_f32_16x16x32_bf16 v[116:119], v[48:51], v[212:215], 0
    ds_read_b64_tr_b16 v[106:107], v2 offset:14336
    v_mul_f32 v188, v88, v188
    v_mul_f32 v189, v88, v189
    v_mul_f32 v190, v88, v190
    v_mul_f32 v191, v88, v191
    v_cvt_pk_bf16_f32 v248, v188, v189
    v_cvt_pk_bf16_f32 v249, v190, v191
    v_mul_f32 v192, v92, v192
    v_mfma_f32_16x16x32_bf16 v[120:123], v[48:51], v[216:219], 0
    ds_read_b64_tr_b16 v[108:109], v3 offset:12288
    v_mul_f32 v193, v92, v193
    v_mul_f32 v194, v92, v194
    v_mul_f32 v195, v92, v195
    v_cvt_pk_bf16_f32 v252, v192, v193
    v_cvt_pk_bf16_f32 v253, v194, v195
    v_mul_f32 v196, v84, v196
    v_mfma_f32_16x16x32_bf16 v[124:127], v[52:55], v[208:211], 0
    ds_read_b64_tr_b16 v[110:111], v3 offset:14336
    v_mul_f32 v197, v84, v197
    v_mul_f32 v198, v84, v198
    v_mul_f32 v199, v84, v199
    v_cvt_pk_bf16_f32 v246, v196, v197
    v_cvt_pk_bf16_f32 v247, v198, v199
    ds_write_b128 v6, v[244:247] offset:9216
    v_mul_f32 v200, v88, v200
    v_mfma_f32_16x16x32_bf16 v[128:131], v[52:55], v[212:215], 0
    v_mul_f32 v201, v88, v201
    v_mul_f32 v202, v88, v202
    v_mul_f32 v203, v88, v203
    v_cvt_pk_bf16_f32 v250, v200, v201
    v_cvt_pk_bf16_f32 v251, v202, v203
    ds_write_b128 v6, v[248:251] offset:10240
    v_mfma_f32_16x16x32_bf16 v[132:135], v[52:55], v[216:219], 0
    v_mul_f32 v204, v92, v204
    v_mul_f32 v205, v92, v205
    v_mul_f32 v206, v92, v206
    v_mul_f32 v207, v92, v207
    v_cvt_pk_bf16_f32 v254, v204, v205
    v_cvt_pk_bf16_f32 v255, v206, v207
    ds_write_b128 v6, v[252:255] offset:11264
    s_waitcnt lgkmcnt(0)
    s_barrier
    v_mfma_f32_16x16x32_bf16 v[112:115], v[72:75], v[220:223], v[112:115]
    ds_read_b128 v[160:163], v7 offset:0
    v_mfma_f32_16x16x32_bf16 v[116:119], v[72:75], v[224:227], v[116:119]
    ds_read_b128 v[164:167], v7 offset:1024
    ds_read_b64_tr_b16 v[48:49], v4 offset:0
    v_mfma_f32_16x16x32_bf16 v[120:123], v[72:75], v[228:231], v[120:123]
    ds_read_b128 v[168:171], v7 offset:2048
    v_mfma_f32_16x16x32_bf16 v[124:127], v[76:79], v[220:223], v[124:127]
    ds_read_b64_tr_b16 v[50:51], v4 offset:2048
    ds_read_b128 v[172:175], v7 offset:3072
    v_mfma_f32_16x16x32_bf16 v[128:131], v[76:79], v[224:227], v[128:131]
    ds_read_b64_tr_b16 v[52:53], v5 offset:0
    v_mfma_f32_16x16x32_bf16 v[132:135], v[76:79], v[228:231], v[132:135]
    ds_read_b64_tr_b16 v[54:55], v5 offset:2048
    v_mfma_f32_16x16x32_bf16 v[112:115], v[96:99], v[232:235], v[112:115]
    ds_read_b128 v[176:179], v7 offset:4096
    v_mfma_f32_16x16x32_bf16 v[116:119], v[96:99], v[236:239], v[116:119]
    ds_read_b128 v[180:183], v7 offset:5120
    ds_read_b64_tr_b16 v[72:73], v4 offset:4096
    v_mfma_f32_16x16x32_bf16 v[120:123], v[96:99], v[240:243], v[120:123]
    ds_read_b128 v[184:187], v7 offset:6144
    v_mfma_f32_16x16x32_bf16 v[124:127], v[100:103], v[232:235], v[124:127]
    ds_read_b64_tr_b16 v[74:75], v4 offset:6144
    ds_read_b128 v[188:191], v7 offset:7168
    v_mfma_f32_16x16x32_bf16 v[128:131], v[100:103], v[236:239], v[128:131]
    ds_read_b64_tr_b16 v[76:77], v5 offset:4096
    v_mfma_f32_16x16x32_bf16 v[132:135], v[100:103], v[240:243], v[132:135]
    ds_read_b64_tr_b16 v[78:79], v5 offset:6144
    v_mfma_f32_16x16x32_bf16 v[112:115], v[104:107], v[244:247], v[112:115]
    ds_read_b128 v[192:195], v7 offset:8192
    s_mov_b32 s59, s58
    v_mfma_f32_16x16x32_bf16 v[116:119], v[104:107], v[248:251], v[116:119]
    ds_read_b128 v[196:199], v7 offset:9216
    ds_read_b64_tr_b16 v[96:97], v4 offset:8192
    s_add_u32 s58, s58, 32768
    v_mfma_f32_16x16x32_bf16 v[120:123], v[104:107], v[252:255], v[120:123]
    ds_read_b128 v[200:203], v7 offset:10240
    s_cmp_eq_u32 s58, 32768
    v_mfma_f32_16x16x32_bf16 v[124:127], v[108:111], v[244:247], v[124:127]
    ds_read_b64_tr_b16 v[98:99], v4 offset:10240
    ds_read_b128 v[204:207], v7 offset:11264
    s_cselect_b32 s58, 98304, s58
    v_mfma_f32_16x16x32_bf16 v[128:131], v[108:111], v[248:251], v[128:131]
    ds_read_b64_tr_b16 v[100:101], v5 offset:8192
    s_cmp_eq_u32 s58, 163840
    v_mfma_f32_16x16x32_bf16 v[132:135], v[108:111], v[252:255], v[132:135]
    ds_read_b64_tr_b16 v[102:103], v5 offset:10240
    s_cselect_b32 s58, 0, s58
    s_sub_u32 s59, s58, s59
    s_waitcnt lgkmcnt(8)
    v_mfma_f32_16x16x32_bf16 v[112:115], v[48:51], v[160:163], v[112:115]
    ds_read_b64_tr_b16 v[104:105], v4 offset:12288
    v_mfma_f32_16x16x32_bf16 v[116:119], v[48:51], v[164:167], v[116:119]
    ds_read_b64_tr_b16 v[106:107], v4 offset:14336
    v_mfma_f32_16x16x32_bf16 v[120:123], v[48:51], v[168:171], v[120:123]
    ds_read_b64_tr_b16 v[108:109], v5 offset:12288
    v_mfma_f32_16x16x32_bf16 v[124:127], v[52:55], v[160:163], v[124:127]
    ds_read_b64_tr_b16 v[110:111], v5 offset:14336
    v_mfma_f32_16x16x32_bf16 v[128:131], v[52:55], v[164:167], v[128:131]
    v_add_u32 v2, s59, v2
    v_add_u32 v3, s59, v3
    v_mfma_f32_16x16x32_bf16 v[132:135], v[52:55], v[168:171], v[132:135]
    v_add_u32 v4, s59, v4
    v_add_u32 v5, s59, v5
    s_waitcnt lgkmcnt(4)
    v_mfma_f32_16x16x32_bf16 v[112:115], v[72:75], v[172:175], v[112:115]
    v_mfma_f32_16x16x32_bf16 v[116:119], v[72:75], v[176:179], v[116:119]
    s_waitcnt lgkmcnt(0)
    s_barrier
    v_mfma_f32_16x16x32_bf16 v[120:123], v[72:75], v[180:183], v[120:123]
    ds_read_b64_tr_b16 v[48:49], v2 offset:0
    v_mfma_f32_16x16x32_bf16 v[124:127], v[76:79], v[172:175], v[124:127]
    ds_read_b64_tr_b16 v[50:51], v2 offset:2048
    v_mfma_f32_16x16x32_bf16 v[128:131], v[76:79], v[176:179], v[128:131]
    ds_read_b64_tr_b16 v[52:53], v3 offset:0
    v_mfma_f32_16x16x32_bf16 v[132:135], v[76:79], v[180:183], v[132:135]
    ds_read_b64_tr_b16 v[54:55], v3 offset:2048
    v_mfma_f32_16x16x32_bf16 v[112:115], v[96:99], v[184:187], v[112:115]
    ds_read_b64_tr_b16 v[72:73], v2 offset:4096
    v_mfma_f32_16x16x32_bf16 v[116:119], v[96:99], v[188:191], v[116:119]
    ds_read_b64_tr_b16 v[74:75], v2 offset:6144
    v_mfma_f32_16x16x32_bf16 v[120:123], v[96:99], v[192:195], v[120:123]
    ds_read_b64_tr_b16 v[76:77], v3 offset:4096
    v_mfma_f32_16x16x32_bf16 v[124:127], v[100:103], v[184:187], v[124:127]
    ds_read_b64_tr_b16 v[78:79], v3 offset:6144
    v_mfma_f32_16x16x32_bf16 v[128:131], v[100:103], v[188:191], v[128:131]
    v_mfma_f32_16x16x32_bf16 v[132:135], v[100:103], v[192:195], v[132:135]
    v_mfma_f32_16x16x32_bf16 v[112:115], v[104:107], v[196:199], v[112:115]
    ds_read_b64_tr_b16 v[96:97], v2 offset:8192
    v_mfma_f32_16x16x32_bf16 v[116:119], v[104:107], v[200:203], v[116:119]
    ds_read_b64_tr_b16 v[98:99], v2 offset:10240
    v_mfma_f32_16x16x32_bf16 v[120:123], v[104:107], v[204:207], v[120:123]
    ds_read_b64_tr_b16 v[100:101], v3 offset:8192
    v_mfma_f32_16x16x32_bf16 v[124:127], v[108:111], v[196:199], v[124:127]
    ds_read_b64_tr_b16 v[102:103], v3 offset:10240
    v_mfma_f32_16x16x32_bf16 v[128:131], v[108:111], v[200:203], v[128:131]
    v_mfma_f32_16x16x32_bf16 v[132:135], v[108:111], v[204:207], v[132:135]
    s_branch L_o
L_ow1:
    ds_write_b128 v9, v[16:19] offset:0
    ds_write_b128 v9, v[20:23] offset:1024
    ds_write_b128 v9, v[24:27] offset:2048
    s_branch L_owr1
L_ow0:
    ds_write_b128 v9, v[16:19] offset:0
    ds_write_b128 v9, v[20:23] offset:1024
    ds_write_b128 v9, v[24:27] offset:2048
    s_branch L_owr0
L_o:
    s_waitcnt lgkmcnt(8)
    v_mfma_f32_16x16x32_bf16 v[136:139], v[48:51], v[208:211], 0
    ds_read_b64_tr_b16 v[104:105], v2 offset:12288
    v_mfma_f32_16x16x32_bf16 v[140:143], v[48:51], v[212:215], 0
    ds_read_b64_tr_b16 v[106:107], v2 offset:14336
    v_cvt_pk_bf16_f32 v16, v112, v113
    v_mfma_f32_16x16x32_bf16 v[144:147], v[48:51], v[216:219], 0
    ds_read_b64_tr_b16 v[108:109], v3 offset:12288
    v_cvt_pk_bf16_f32 v17, v114, v115
    v_mfma_f32_16x16x32_bf16 v[148:151], v[52:55], v[208:211], 0
    ds_read_b64_tr_b16 v[110:111], v3 offset:14336
    v_cvt_pk_bf16_f32 v18, v124, v125
    v_mfma_f32_16x16x32_bf16 v[152:155], v[52:55], v[212:215], 0
    v_cvt_pk_bf16_f32 v19, v126, v127
    v_mfma_f32_16x16x32_bf16 v[156:159], v[52:55], v[216:219], 0
    s_waitcnt lgkmcnt(8)
    v_mfma_f32_16x16x32_bf16 v[136:139], v[72:75], v[220:223], v[136:139]
    ds_read_b64_tr_b16 v[48:49], v4 offset:0
    v_mfma_f32_16x16x32_bf16 v[140:143], v[72:75], v[224:227], v[140:143]
    ds_read_b64_tr_b16 v[50:51], v4 offset:2048
    v_cvt_pk_bf16_f32 v20, v116, v117
    v_mfma_f32_16x16x32_bf16 v[144:147], v[72:75], v[228:231], v[144:147]
    ds_read_b64_tr_b16 v[52:53], v5 offset:0
    v_cvt_pk_bf16_f32 v21, v118, v119
    v_mfma_f32_16x16x32_bf16 v[148:151], v[76:79], v[220:223], v[148:151]
    ds_read_b64_tr_b16 v[54:55], v5 offset:2048
    v_cvt_pk_bf16_f32 v22, v128, v129
    v_mfma_f32_16x16x32_bf16 v[152:155], v[76:79], v[224:227], v[152:155]
    v_cvt_pk_bf16_f32 v23, v130, v131
    v_mfma_f32_16x16x32_bf16 v[156:159], v[76:79], v[228:231], v[156:159]
    s_cmp_eq_u32 s57, s60
    s_cselect_b32 s46, 0, 110592
    s_waitcnt lgkmcnt(8)
    v_mfma_f32_16x16x32_bf16 v[136:139], v[96:99], v[232:235], v[136:139]
    ds_read_b64_tr_b16 v[72:73], v4 offset:4096
    v_mfma_f32_16x16x32_bf16 v[140:143], v[96:99], v[236:239], v[140:143]
    ds_read_b64_tr_b16 v[74:75], v4 offset:6144
    v_cvt_pk_bf16_f32 v24, v120, v121
    v_mfma_f32_16x16x32_bf16 v[144:147], v[96:99], v[240:243], v[144:147]
    ds_read_b64_tr_b16 v[76:77], v5 offset:4096
    v_cvt_pk_bf16_f32 v25, v122, v123
    v_mfma_f32_16x16x32_bf16 v[148:151], v[100:103], v[232:235], v[148:151]
    ds_read_b64_tr_b16 v[78:79], v5 offset:6144
    v_cvt_pk_bf16_f32 v26, v132, v133
    v_mfma_f32_16x16x32_bf16 v[152:155], v[100:103], v[236:239], v[152:155]
    v_cvt_pk_bf16_f32 v27, v134, v135
    v_mfma_f32_16x16x32_bf16 v[156:159], v[100:103], v[240:243], v[156:159]
    s_cbranch_scc1 L_ow1
L_owr1:
    s_waitcnt lgkmcnt(8)
    v_mfma_f32_16x16x32_bf16 v[136:139], v[104:107], v[244:247], v[136:139]
    ds_read_b64_tr_b16 v[96:97], v4 offset:8192
    s_mov_b32 s59, s58
    v_mfma_f32_16x16x32_bf16 v[140:143], v[104:107], v[248:251], v[140:143]
    ds_read_b64_tr_b16 v[98:99], v4 offset:10240
    s_add_u32 s58, s58, 32768
    v_mfma_f32_16x16x32_bf16 v[144:147], v[104:107], v[252:255], v[144:147]
    ds_read_b64_tr_b16 v[100:101], v5 offset:8192
    s_cmp_eq_u32 s58, 32768
    v_mfma_f32_16x16x32_bf16 v[148:151], v[108:111], v[244:247], v[148:151]
    ds_read_b64_tr_b16 v[102:103], v5 offset:10240
    s_cselect_b32 s58, 98304, s58
    v_mfma_f32_16x16x32_bf16 v[152:155], v[108:111], v[248:251], v[152:155]
    s_cmp_eq_u32 s58, 163840
    v_mfma_f32_16x16x32_bf16 v[156:159], v[108:111], v[252:255], v[156:159]
    s_cselect_b32 s58, 0, s58
    s_sub_u32 s59, s58, s59
    s_waitcnt lgkmcnt(8)
    v_mfma_f32_16x16x32_bf16 v[136:139], v[48:51], v[160:163], v[136:139]
    ds_read_b64_tr_b16 v[104:105], v4 offset:12288
    v_mfma_f32_16x16x32_bf16 v[140:143], v[48:51], v[164:167], v[140:143]
    ds_read_b64_tr_b16 v[106:107], v4 offset:14336
    v_mfma_f32_16x16x32_bf16 v[144:147], v[48:51], v[168:171], v[144:147]
    ds_read_b64_tr_b16 v[108:109], v5 offset:12288
    v_mfma_f32_16x16x32_bf16 v[148:151], v[52:55], v[160:163], v[148:151]
    ds_read_b64_tr_b16 v[110:111], v5 offset:14336
    v_mfma_f32_16x16x32_bf16 v[152:155], v[52:55], v[164:167], v[152:155]
    v_add_u32 v2, s59, v2
    v_add_u32 v3, s59, v3
    v_mfma_f32_16x16x32_bf16 v[156:159], v[52:55], v[168:171], v[156:159]
    v_add_u32 v4, s59, v4
    v_add_u32 v5, s59, v5
    s_waitcnt lgkmcnt(8)
    v_mfma_f32_16x16x32_bf16 v[136:139], v[72:75], v[172:175], v[136:139]
    v_mfma_f32_16x16x32_bf16 v[140:143], v[72:75], v[176:179], v[140:143]
    s_waitcnt vmcnt(6) lgkmcnt(0)
    s_barrier
    v_mfma_f32_16x16x32_bf16 v[144:147], v[72:75], v[180:183], v[144:147]
    buffer_store_dwordx4 v[16:19], v8, s[44:47], s57 offen offset:0 sc1
    ds_read_b64_tr_b16 v[48:49], v2 offset:0
    v_mfma_f32_16x16x32_bf16 v[148:151], v[76:79], v[172:175], v[148:151]
    ds_read_b64_tr_b16 v[50:51], v2 offset:2048
    v_mfma_f32_16x16x32_bf16 v[152:155], v[76:79], v[176:179], v[152:155]
    ds_read_b64_tr_b16 v[52:53], v3 offset:0
    v_mfma_f32_16x16x32_bf16 v[156:159], v[76:79], v[180:183], v[156:159]
    ds_read_b64_tr_b16 v[54:55], v3 offset:2048
    v_mfma_f32_16x16x32_bf16 v[136:139], v[96:99], v[184:187], v[136:139]
    buffer_store_dwordx4 v[20:23], v8, s[44:47], s57 offen offset:1024 sc1
    ds_read_b64_tr_b16 v[72:73], v2 offset:4096
    v_mfma_f32_16x16x32_bf16 v[140:143], v[96:99], v[188:191], v[140:143]
    ds_read_b64_tr_b16 v[74:75], v2 offset:6144
    v_mfma_f32_16x16x32_bf16 v[144:147], v[96:99], v[192:195], v[144:147]
    ds_read_b64_tr_b16 v[76:77], v3 offset:4096
    v_mfma_f32_16x16x32_bf16 v[148:151], v[100:103], v[184:187], v[148:151]
    ds_read_b64_tr_b16 v[78:79], v3 offset:6144
    v_mfma_f32_16x16x32_bf16 v[152:155], v[100:103], v[188:191], v[152:155]
    v_mfma_f32_16x16x32_bf16 v[156:159], v[100:103], v[192:195], v[156:159]
    buffer_store_dwordx4 v[24:27], v8, s[44:47], s57 offen offset:2048 sc1
    v_mfma_f32_16x16x32_bf16 v[136:139], v[104:107], v[196:199], v[136:139]
    ds_read_b64_tr_b16 v[96:97], v2 offset:8192
    v_mfma_f32_16x16x32_bf16 v[140:143], v[104:107], v[200:203], v[140:143]
    ds_read_b64_tr_b16 v[98:99], v2 offset:10240
    v_mfma_f32_16x16x32_bf16 v[144:147], v[104:107], v[204:207], v[144:147]
    ds_read_b64_tr_b16 v[100:101], v3 offset:8192
    v_mfma_f32_16x16x32_bf16 v[148:151], v[108:111], v[196:199], v[148:151]
    ds_read_b64_tr_b16 v[102:103], v3 offset:10240
    v_mfma_f32_16x16x32_bf16 v[152:155], v[108:111], v[200:203], v[152:155]
    v_mfma_f32_16x16x32_bf16 v[156:159], v[108:111], v[204:207], v[156:159]
    s_addk_i32 s57, 12288
    s_waitcnt lgkmcnt(8)
    v_mfma_f32_16x16x32_bf16 v[112:115], v[48:51], v[208:211], 0
    ds_read_b64_tr_b16 v[104:105], v2 offset:12288
    v_mfma_f32_16x16x32_bf16 v[116:119], v[48:51], v[212:215], 0
    ds_read_b64_tr_b16 v[106:107], v2 offset:14336
    v_cvt_pk_bf16_f32 v16, v136, v137
    v_mfma_f32_16x16x32_bf16 v[120:123], v[48:51], v[216:219], 0
    ds_read_b64_tr_b16 v[108:109], v3 offset:12288
    v_cvt_pk_bf16_f32 v17, v138, v139
    v_mfma_f32_16x16x32_bf16 v[124:127], v[52:55], v[208:211], 0
    ds_read_b64_tr_b16 v[110:111], v3 offset:14336
    v_cvt_pk_bf16_f32 v18, v148, v149
    v_mfma_f32_16x16x32_bf16 v[128:131], v[52:55], v[212:215], 0
    v_cvt_pk_bf16_f32 v19, v150, v151
    v_mfma_f32_16x16x32_bf16 v[132:135], v[52:55], v[216:219], 0
    s_waitcnt lgkmcnt(8)
    v_mfma_f32_16x16x32_bf16 v[112:115], v[72:75], v[220:223], v[112:115]
    ds_read_b64_tr_b16 v[48:49], v4 offset:0
    v_mfma_f32_16x16x32_bf16 v[116:119], v[72:75], v[224:227], v[116:119]
    ds_read_b64_tr_b16 v[50:51], v4 offset:2048
    v_cvt_pk_bf16_f32 v20, v140, v141
    v_mfma_f32_16x16x32_bf16 v[120:123], v[72:75], v[228:231], v[120:123]
    ds_read_b64_tr_b16 v[52:53], v5 offset:0
    v_cvt_pk_bf16_f32 v21, v142, v143
    v_mfma_f32_16x16x32_bf16 v[124:127], v[76:79], v[220:223], v[124:127]
    ds_read_b64_tr_b16 v[54:55], v5 offset:2048
    v_cvt_pk_bf16_f32 v22, v152, v153
    v_mfma_f32_16x16x32_bf16 v[128:131], v[76:79], v[224:227], v[128:131]
    v_cvt_pk_bf16_f32 v23, v154, v155
    v_mfma_f32_16x16x32_bf16 v[132:135], v[76:79], v[228:231], v[132:135]
    s_cmp_eq_u32 s57, s60
    s_cselect_b32 s46, 0, 110592
    s_waitcnt lgkmcnt(8)
    v_mfma_f32_16x16x32_bf16 v[112:115], v[96:99], v[232:235], v[112:115]
    ds_read_b64_tr_b16 v[72:73], v4 offset:4096
    v_mfma_f32_16x16x32_bf16 v[116:119], v[96:99], v[236:239], v[116:119]
    ds_read_b64_tr_b16 v[74:75], v4 offset:6144
    v_cvt_pk_bf16_f32 v24, v144, v145
    v_mfma_f32_16x16x32_bf16 v[120:123], v[96:99], v[240:243], v[120:123]
    ds_read_b64_tr_b16 v[76:77], v5 offset:4096
    v_cvt_pk_bf16_f32 v25, v146, v147
    v_mfma_f32_16x16x32_bf16 v[124:127], v[100:103], v[232:235], v[124:127]
    ds_read_b64_tr_b16 v[78:79], v5 offset:6144
    v_cvt_pk_bf16_f32 v26, v156, v157
    v_mfma_f32_16x16x32_bf16 v[128:131], v[100:103], v[236:239], v[128:131]
    v_cvt_pk_bf16_f32 v27, v158, v159
    v_mfma_f32_16x16x32_bf16 v[132:135], v[100:103], v[240:243], v[132:135]
    s_cbranch_scc1 L_ow0
L_owr0:
    s_waitcnt lgkmcnt(8)
    v_mfma_f32_16x16x32_bf16 v[112:115], v[104:107], v[244:247], v[112:115]
    ds_read_b64_tr_b16 v[96:97], v4 offset:8192
    s_mov_b32 s59, s58
    v_mfma_f32_16x16x32_bf16 v[116:119], v[104:107], v[248:251], v[116:119]
    ds_read_b64_tr_b16 v[98:99], v4 offset:10240
    s_add_u32 s58, s58, 32768
    v_mfma_f32_16x16x32_bf16 v[120:123], v[104:107], v[252:255], v[120:123]
    ds_read_b64_tr_b16 v[100:101], v5 offset:8192
    s_cmp_eq_u32 s58, 32768
    v_mfma_f32_16x16x32_bf16 v[124:127], v[108:111], v[244:247], v[124:127]
    ds_read_b64_tr_b16 v[102:103], v5 offset:10240
    s_cselect_b32 s58, 98304, s58
    v_mfma_f32_16x16x32_bf16 v[128:131], v[108:111], v[248:251], v[128:131]
    s_cmp_eq_u32 s58, 163840
    v_mfma_f32_16x16x32_bf16 v[132:135], v[108:111], v[252:255], v[132:135]
    s_cselect_b32 s58, 0, s58
    s_sub_u32 s59, s58, s59
    s_waitcnt lgkmcnt(8)
    v_mfma_f32_16x16x32_bf16 v[112:115], v[48:51], v[160:163], v[112:115]
    ds_read_b64_tr_b16 v[104:105], v4 offset:12288
    v_mfma_f32_16x16x32_bf16 v[116:119], v[48:51], v[164:167], v[116:119]
    ds_read_b64_tr_b16 v[106:107], v4 offset:14336
    v_mfma_f32_16x16x32_bf16 v[120:123], v[48:51], v[168:171], v[120:123]
    ds_read_b64_tr_b16 v[108:109], v5 offset:12288
    v_mfma_f32_16x16x32_bf16 v[124:127], v[52:55], v[160:163], v[124:127]
    ds_read_b64_tr_b16 v[110:111], v5 offset:14336
    s_sub_u32 s48, s48, 1
    v_mfma_f32_16x16x32_bf16 v[128:131], v[52:55], v[164:167], v[128:131]
    v_add_u32 v2, s59, v2
    v_add_u32 v3, s59, v3
    v_mfma_f32_16x16x32_bf16 v[132:135], v[52:55], v[168:171], v[132:135]
    v_add_u32 v4, s59, v4
    v_add_u32 v5, s59, v5
    s_cmp_eq_u32 s48, 0
    s_waitcnt lgkmcnt(8)
    v_mfma_f32_16x16x32_bf16 v[112:115], v[72:75], v[172:175], v[112:115]
    v_mfma_f32_16x16x32_bf16 v[116:119], v[72:75], v[176:179], v[116:119]
    s_waitcnt lgkmcnt(0)
    s_cbranch_scc1 L_onb
    s_barrier
L_onb:
    v_mfma_f32_16x16x32_bf16 v[120:123], v[72:75], v[180:183], v[120:123]
    buffer_store_dwordx4 v[16:19], v8, s[44:47], s57 offen offset:0 sc1
    ds_read_b64_tr_b16 v[48:49], v2 offset:0
    v_mfma_f32_16x16x32_bf16 v[124:127], v[76:79], v[172:175], v[124:127]
    ds_read_b64_tr_b16 v[50:51], v2 offset:2048
    v_mfma_f32_16x16x32_bf16 v[128:131], v[76:79], v[176:179], v[128:131]
    ds_read_b64_tr_b16 v[52:53], v3 offset:0
    v_mfma_f32_16x16x32_bf16 v[132:135], v[76:79], v[180:183], v[132:135]
    ds_read_b64_tr_b16 v[54:55], v3 offset:2048
    v_mfma_f32_16x16x32_bf16 v[112:115], v[96:99], v[184:187], v[112:115]
    buffer_store_dwordx4 v[20:23], v8, s[44:47], s57 offen offset:1024 sc1
    ds_read_b64_tr_b16 v[72:73], v2 offset:4096
    v_mfma_f32_16x16x32_bf16 v[116:119], v[96:99], v[188:191], v[116:119]
    ds_read_b64_tr_b16 v[74:75], v2 offset:6144
    v_mfma_f32_16x16x32_bf16 v[120:123], v[96:99], v[192:195], v[120:123]
    ds_read_b64_tr_b16 v[76:77], v3 offset:4096
    v_mfma_f32_16x16x32_bf16 v[124:127], v[100:103], v[184:187], v[124:127]
    ds_read_b64_tr_b16 v[78:79], v3 offset:6144
    v_mfma_f32_16x16x32_bf16 v[128:131], v[100:103], v[188:191], v[128:131]
    v_mfma_f32_16x16x32_bf16 v[132:135], v[100:103], v[192:195], v[132:135]
    buffer_store_dwordx4 v[24:27], v8, s[44:47], s57 offen offset:2048 sc1
    v_mfma_f32_16x16x32_bf16 v[112:115], v[104:107], v[196:199], v[112:115]
    ds_read_b64_tr_b16 v[96:97], v2 offset:8192
    v_mfma_f32_16x16x32_bf16 v[116:119], v[104:107], v[200:203], v[116:119]
    ds_read_b64_tr_b16 v[98:99], v2 offset:10240
    v_mfma_f32_16x16x32_bf16 v[120:123], v[104:107], v[204:207], v[120:123]
    ds_read_b64_tr_b16 v[100:101], v3 offset:8192
    v_mfma_f32_16x16x32_bf16 v[124:127], v[108:111], v[196:199], v[124:127]
    ds_read_b64_tr_b16 v[102:103], v3 offset:10240
    v_mfma_f32_16x16x32_bf16 v[128:131], v[108:111], v[200:203], v[128:131]
    v_mfma_f32_16x16x32_bf16 v[132:135], v[108:111], v[204:207], v[132:135]
    s_addk_i32 s57, 12288
    s_cmp_eq_u32 s48, 0
    s_cbranch_scc0 L_o
    s_mov_b32 s46, 110592
    s_nop 3
    v_cvt_pk_bf16_f32 v16, v112, v113
    v_cvt_pk_bf16_f32 v17, v114, v115
    v_cvt_pk_bf16_f32 v18, v124, v125
    v_cvt_pk_bf16_f32 v19, v126, v127
    buffer_store_dwordx4 v[16:19], v8, s[44:47], s57 offen offset:0 sc1
    v_cvt_pk_bf16_f32 v20, v116, v117
    v_cvt_pk_bf16_f32 v21, v118, v119
    v_cvt_pk_bf16_f32 v22, v128, v129
    v_cvt_pk_bf16_f32 v23, v130, v131
    buffer_store_dwordx4 v[20:23], v8, s[44:47], s57 offen offset:1024 sc1
    v_cvt_pk_bf16_f32 v24, v120, v121
    v_cvt_pk_bf16_f32 v25, v122, v123
    v_cvt_pk_bf16_f32 v26, v132, v133
    v_cvt_pk_bf16_f32 v27, v134, v135
    buffer_store_dwordx4 v[24:27], v8, s[44:47], s57 offen offset:2048 sc1
    s_waitcnt lgkmcnt(0)
L_red:
    s_mul_i32 s50, s21, 1769472
    s_add_u32 s72, s18, s50
    s_addc_u32 s73, s19, 0
    s_mov_b32 s74, 1769472
    s_mov_b32 s75, 0x20000
    s_mul_i32 s50, s21, 110592
    s_add_u32 s76, s14, s50
    s_addc_u32 s77, s15, 0
    s_mov_b32 s78, 110592
    s_mov_b32 s79, 0x20000
    v_lshrrev_b32 v100, 4, v0
    v_bfe_u32 v101, v0, 3, 1
    v_and_b32 v102, 7, v0
    v_mul_u32_u24 v103, 110592, v100
    v_lshl_add_u32 v103, v101, 9, v103
    v_lshl_add_u32 v103, v102, 4, v103
    v_mul_u32_u24 v104, 1152, v102
    v_lshl_add_u32 v104, v100, 5, v104
    v_lshl_add_u32 v104, v101, 4, v104
    v_and_b32 v105, 1, v0
    v_lshlrev_b32 v105, 4, v105
    v_mov_b32 v106, 0x3f80
    v_lshlrev_b32 v105, v105, v106
    v_bfe_u32 v106, v0, 1, 3
    v_lshlrev_b32 v106, v106, 1
    v_bfe_i32 v108, v106, 0, 1
    v_bfe_i32 v109, v106, 1, 1
    v_bfe_i32 v110, v106, 2, 1
    v_bfe_i32 v111, v106, 3, 1
    v_bfe_i32 v112, v106, 4, 1
    v_bfe_i32 v113, v106, 5, 1
    v_bfe_i32 v114, v106, 6, 1
    v_bfe_i32 v115, v106, 7, 1
    v_and_b32 v108, v108, v105
    v_and_b32 v109, v109, v105
    v_and_b32 v110, v110, v105
    v_and_b32 v111, v111, v105
    v_and_b32 v112, v112, v105
    v_and_b32 v113, v113, v105
    v_and_b32 v114, v114, v105
    v_and_b32 v115, v115, v105
    v_mov_b32 v107, 81920
    s_lshr_b32 s50, s20, 1
    s_lshl_b32 s50, s50, 3
    s_and_b32 s51, s20, 1
    s_add_u32 s50, s50, s51
    s_lshl_b32 s50, s50, 7
    s_add_u32 s50, s50, 82944
    v_lshlrev_b32 v99, 4, v102
    v_lshl_add_u32 v99, v101, 9, v99
    v_add_u32 v99, s50, v99
    s_lshl_b32 s50, s22, 4
    s_lshl_b64 s[94:95], 0xffff, s50
    s_not_b64 s[94:95], s[94:95]
    s_lshr_b32 s99, s22, 2
    s_cmp_lt_u32 s20, 6
    s_cselect_b32 s99, s99, 8
    s_lshl_b32 s84, 1, s22
    s_mov_b32 s82, s20
    s_mov_b32 s83, 1
    s_mov_b32 s81, 2097152
    s_waitcnt vmcnt(0)
    s_barrier
L_own:
    s_cmp_eq_u32 s84, 0
    s_cbranch_scc1 L_rdone
    s_ff1_i32_b32 s85, s84
    s_bitset0_b32 s84, s85
    s_lshl_b32 s86, s82, 4
    s_add_u32 s86, s86, s85
    s_mov_b32 s87, s83
L_unit:
    s_cmp_ge_u32 s86, 108
    s_cbranch_scc1 L_own
    s_lshr_b32 s51, s86, 4
    s_and_b32 s50, s86, 15
    s_sub_u32 s52, s50, 6
    s_cselect_b32 s52, s50, s52
    s_cselect_b32 s53, 16, 17
    s_cmp_lt_u32 s51, 6
    s_cselect_b32 s50, s50, s53
    s_cselect_b32 s51, s51, s52
    s_mul_i32 s91, s50, 6144
    s_and_b32 s52, s51, 1
    s_mul_i32 s52, s52, 384
    s_lshl_b32 s53, s51, 9
    s_sub_u32 s53, s53, s52
    s_add_u32 s91, s91, s53
    s_lshr_b32 s92, s50, 1
    s_lshl_b32 s92, s92, 7
    s_and_b32 s50, s50, 1
    s_mul_i32 s50, s50, 6
    s_add_u32 s50, s50, s51
    s_mul_i32 s50, s50, 9216
    s_add_u32 s92, s92, s50
    s_mov_b32 s80, 31
    s_mov_b32 s98, 0
L_m0:
    ds_read_b128 v[8:11], v107
    s_sub_u32 s81, s81, 1
    s_cbranch_scc1 L_rdone
    s_waitcnt lgkmcnt(0)
    v_readfirstlane_b32 s50, v8
    s_and_b32 s98, s50, s80
    s_cbranch_scc0 L_m0
L_g0:
    s_ff1_i32_b32 s50, s98
    s_cmp_eq_u32 s50, 4
    s_cbranch_scc1 L_rdone
    s_bitset0_b32 s98, s50
    s_bitset0_b32 s80, s50
    s_cmp_eq_u32 s50, s99
    s_cselect_b64 exec, s[94:95], -1
    s_mul_i32 s50, s50, 442368
    s_add_u32 s50, s50, s91
    buffer_load_dwordx4 v[16:19], v103, s[72:75], s50 offen offset:0 sc1
    buffer_load_dwordx4 v[20:23], v103, s[72:75], s50 offen offset:256 sc1
    buffer_load_dwordx4 v[24:27], v103, s[72:75], s50 offen offset:3072 sc1
    buffer_load_dwordx4 v[28:31], v103, s[72:75], s50 offen offset:3328 sc1
    s_not_b64 exec, exec
    ds_read_b128 v[16:19], v99 offset:0
    ds_read_b128 v[20:23], v99 offset:256
    ds_read_b128 v[24:27], v99 offset:3072
    ds_read_b128 v[28:31], v99 offset:3328
    s_mov_b64 exec, -1
    s_cmp_lg_u32 s98, 0
    s_cbranch_scc1 L_g1
L_m1:
    ds_read_b128 v[8:11], v107
    s_sub_u32 s81, s81, 1
    s_cbranch_scc1 L_rdone
    s_waitcnt lgkmcnt(0)
    v_readfirstlane_b32 s50, v8
    s_and_b32 s98, s50, s80
    s_cbranch_scc0 L_m1
L_g1:
    s_ff1_i32_b32 s50, s98
    s_cmp_eq_u32 s50, 4
    s_cbranch_scc1 L_rdone
    s_bitset0_b32 s98, s50
    s_bitset0_b32 s80, s50
    s_cmp_eq_u32 s50, s99
    s_cselect_b64 exec, s[94:95], -1
    s_mul_i32 s50, s50, 442368
    s_add_u32 s50, s50, s91
    buffer_load_dwordx4 v[32:35], v103, s[72:75], s50 offen offset:0 sc1
    buffer_load_dwordx4 v[36:39], v103, s[72:75], s50 offen offset:256 sc1
    buffer_load_dwordx4 v[40:43], v103, s[72:75], s50 offen offset:3072 sc1
    buffer_load_dwordx4 v[44:47], v103, s[72:75], s50 offen offset:3328 sc1
    s_not_b64 exec, exec
    ds_read_b128 v[32:35], v99 offset:0
    ds_read_b128 v[36:39], v99 offset:256
    ds_read_b128 v[40:43], v99 offset:3072
    ds_read_b128 v[44:47], v99 offset:3328
    s_mov_b64 exec, -1
    s_cmp_lg_u32 s98, 0
    s_cbranch_scc1 L_g2
L_m2:
    ds_read_b128 v[8:11], v107
    s_sub_u32 s81, s81, 1
    s_cbranch_scc1 L_rdone
    s_waitcnt lgkmcnt(0)
    v_readfirstlane_b32 s50, v8
    s_and_b32 s98, s50, s80
    s_cbranch_scc0 L_m2
L_g2:
    s_ff1_i32_b32 s50, s98
    s_cmp_eq_u32 s50, 4
    s_cbranch_scc1 L_rdone
    s_bitset0_b32 s98, s50
    s_bitset0_b32 s80, s50
    s_cmp_eq_u32 s50, s99
    s_cselect_b64 exec, s[94:95], -1
    s_mul_i32 s50, s50, 442368
    s_add_u32 s50, s50, s91
    buffer_load_dwordx4 v[48:51], v103, s[72:75], s50 offen offset:0 sc1
    buffer_load_dwordx4 v[52:55], v103, s[72:75], s50 offen offset:256 sc1
    buffer_load_dwordx4 v[56:59], v103, s[72:75], s50 offen offset:3072 sc1
    buffer_load_dwordx4 v[60:63], v103, s[72:75], s50 offen offset:3328 sc1
    s_not_b64 exec, exec
    ds_read_b128 v[48:51], v99 offset:0
    ds_read_b128 v[52:55], v99 offset:256
    ds_read_b128 v[56:59], v99 offset:3072
    ds_read_b128 v[60:63], v99 offset:3328
    s_mov_b64 exec, -1
    s_cmp_lg_u32 s98, 0
    s_cbranch_scc1 L_g3
L_m3:
    ds_read_b128 v[8:11], v107
    s_sub_u32 s81, s81, 1
    s_cbranch_scc1 L_rdone
    s_waitcnt lgkmcnt(0)
    v_readfirstlane_b32 s50, v8
    s_and_b32 s98, s50, s80
    s_cbranch_scc0 L_m3
L_g3:
    s_ff1_i32_b32 s50, s98
    s_cmp_eq_u32 s50, 4
    s_cbranch_scc1 L_rdone
    s_bitset0_b32 s98, s50
    s_bitset0_b32 s80, s50
    s_cmp_eq_u32 s50, s99
    s_cselect_b64 exec, s[94:95], -1
    s_mul_i32 s50, s50, 442368
    s_add_u32 s50, s50, s91
    buffer_load_dwordx4 v[64:67], v103, s[72:75], s50 offen offset:0 sc1
    buffer_load_dwordx4 v[68:71], v103, s[72:75], s50 offen offset:256 sc1
    buffer_load_dwordx4 v[72:75], v103, s[72:75], s50 offen offset:3072 sc1
    buffer_load_dwordx4 v[76:79], v103, s[72:75], s50 offen offset:3328 sc1
    s_not_b64 exec, exec
    ds_read_b128 v[64:67], v99 offset:0
    ds_read_b128 v[68:71], v99 offset:256
    ds_read_b128 v[72:75], v99 offset:3072
    ds_read_b128 v[76:79], v99 offset:3328
    s_mov_b64 exec, -1
    s_waitcnt vmcnt(14) lgkmcnt(0)
    v_mfma_f32_16x16x32_bf16 v[120:123], v[108:111], v[16:19], 0
    v_mfma_f32_16x16x32_bf16 v[124:127], v[108:111], v[20:23], 0
    s_waitcnt vmcnt(12)
    v_mfma_f32_16x16x32_bf16 v[120:123], v[112:115], v[24:27], v[120:123]
    v_mfma_f32_16x16x32_bf16 v[124:127], v[112:115], v[28:31], v[124:127]
    s_waitcnt vmcnt(10)
    v_mfma_f32_16x16x32_bf16 v[120:123], v[108:111], v[32:35], v[120:123]
    v_mfma_f32_16x16x32_bf16 v[124:127], v[108:111], v[36:39], v[124:127]
    s_waitcnt vmcnt(8)
    v_mfma_f32_16x16x32_bf16 v[120:123], v[112:115], v[40:43], v[120:123]
    v_mfma_f32_16x16x32_bf16 v[124:127], v[112:115], v[44:47], v[124:127]
    s_waitcnt vmcnt(6)
    v_mfma_f32_16x16x32_bf16 v[120:123], v[108:111], v[48:51], v[120:123]
    v_mfma_f32_16x16x32_bf16 v[124:127], v[108:111], v[52:55], v[124:127]
    s_waitcnt vmcnt(4)
    v_mfma_f32_16x16x32_bf16 v[120:123], v[112:115], v[56:59], v[120:123]
    v_mfma_f32_16x16x32_bf16 v[124:127], v[112:115], v[60:63], v[124:127]
    s_waitcnt vmcnt(2)
    v_mfma_f32_16x16x32_bf16 v[120:123], v[108:111], v[64:67], v[120:123]
    v_mfma_f32_16x16x32_bf16 v[124:127], v[108:111], v[68:71], v[124:127]
    s_waitcnt vmcnt(0)
    v_mfma_f32_16x16x32_bf16 v[120:123], v[112:115], v[72:75], v[120:123]
    v_mfma_f32_16x16x32_bf16 v[124:127], v[112:115], v[76:79], v[124:127]
    s_nop 7
    v_cvt_pk_bf16_f32 v116, v120, v121
    v_cvt_pk_bf16_f32 v117, v122, v123
    v_cvt_pk_bf16_f32 v118, v124, v125
    v_cvt_pk_bf16_f32 v119, v126, v127
    buffer_store_dwordx4 v[116:119], v104, s[76:79], s92 offen
    s_add_u32 s86, s86, 16
    s_sub_u32 s87, s87, 1
    s_cmp_gt_u32 s87, 0
    s_cbranch_scc1 L_unit
    s_branch L_own
L_rdone:
    s_endpgm
L_poll:
    s_waitcnt vmcnt(0)
    s_barrier
    s_mov_b64 exec, 1
    buffer_store_dword v21, v22, s[68:71], 0 offen sc1
    s_mov_b64 exec, -1
    s_mov_b32 s89, 600
    s_mov_b32 s90, 0
    s_mov_b32 s81, 2097152
    s_lshl_b32 s84, 1, s22
L_hs:
    v_readfirstlane_b32 s50, v20
    s_cmp_eq_u32 s50, 16
    s_cbranch_scc1 L_pf
L_hsl:
    buffer_load_dword v20, v50, s[64:67], s93 offen sc1
    s_waitcnt vmcnt(0)
    s_sub_u32 s89, s89, 1
    s_cmp_gt_u32 s89, 0
    s_cbranch_scc1 L_hs
    s_branch L_to
L_pf:
    buffer_load_dword v23, v24, s[68:71], 0 offen sc1
    s_sub_u32 s89, s89, 1
    s_waitcnt vmcnt(0)
    v_cmp_ne_u32 vcc, 1, v23
    s_nop 0
    s_quadmask_b32 s50, vcc_lo
    s_andn2_b32 s50, 15, s50
    v_mov_b32 v25, s50
    ds_write_b32 v107, v25
    s_cbranch_vccz L_go
    s_cmp_gt_u32 s89, 0
    s_cbranch_scc1 L_pf
L_to:
    s_cmp_eq_u32 s90, 1
    s_cbranch_scc1 L_quit
    v_lshlrev_b32 v27, 4, v0
    v_add_u32 v26, 82944, v27
    s_mul_i32 s91, s22, 6144
    s_add_u32 s92, s91, 3072
    ds_read_b128 v[64:67], v26 offset:0
    ds_read_b128 v[68:71], v26 offset:1024
    ds_read_b128 v[72:75], v26 offset:2048
    ds_read_b128 v[76:79], v26 offset:3072
    ds_read_b128 v[80:83], v26 offset:4096
    ds_read_b128 v[84:87], v26 offset:5120
    s_waitcnt lgkmcnt(0)
    buffer_store_dwordx4 v[64:67], v27, s[44:47], s91 offen offset:0 sc1
    buffer_store_dwordx4 v[68:71], v27, s[44:47], s91 offen offset:1024 sc1
    buffer_store_dwordx4 v[72:75], v27, s[44:47], s91 offen offset:2048 sc1
    buffer_store_dwordx4 v[76:79], v27, s[44:47], s92 offen offset:0 sc1
    buffer_store_dwordx4 v[80:83], v27, s[44:47], s92 offen offset:1024 sc1
    buffer_store_dwordx4 v[84:87], v27, s[44:47], s92 offen offset:2048 sc1
    s_waitcnt vmcnt(0)
    s_mov_b64 exec, 1
    buffer_store_dword v21, v22, s[68:71], 0 offen offset:4 sc1
    s_mov_b64 exec, -1
    s_mov_b32 s90, 1
    s_mov_b32 s89, 2
    s_waitcnt vmcnt(0)
    s_branch L_hsl
L_quit:
    v_mov_b32 v25, 16
    ds_write_b32 v107, v25
    s_waitcnt lgkmcnt(0)
    s_endpgm
L_go:
    buffer_load_dword v23, v24, s[68:71], 0 offen offset:4 sc1
    s_mov_b32 s82, 0
    s_mov_b32 s83, 7
    s_mov_b32 s99, 8
    s_waitcnt vmcnt(0)
    v_cmp_eq_u32 vcc, 1, v23
    s_nop 1
    s_and_b32 s84, vcc_lo, 0xffff
    s_bitset0_b32 s84, s22
    s_branch L_own
L_loaders:
    s_cmp_eq_u32 s20, 6
    s_cbranch_scc1 L_ldx
    s_cmp_eq_u32 s20, 7
    s_cbranch_scc1 L_ldk
    s_sub_u32 s60, s20, 4
    v_lshrrev_b32 v10, 5, v0
    v_bfe_u32 v11, v0, 2, 2
    v_and_b32 v12, 0x13, v0
    v_lshlrev_b32 v12, 4, v12
    v_add_u32 v13, 0, v10
    v_and_b32 v14, 3, v13
    v_xor_b32 v14, v14, v11
    v_lshl_add_u32 v14, v14, 6, v12
    v_lshl_add_u32 v14, v13, 13, v14
    v_subrev_u32 v2, 0, v14
    v_add_u32 v13, 2, v10
    v_and_b32 v14, 3, v13
    v_xor_b32 v14, v14, v11
    v_lshl_add_u32 v14, v14, 6, v12
    v_lshl_add_u32 v14, v13, 13, v14
    v_subrev_u32 v3, 1024, v14
    v_add_u32 v13, 4, v10
    v_and_b32 v14, 3, v13
    v_xor_b32 v14, v14, v11
    v_lshl_add_u32 v14, v14, 6, v12
    v_lshl_add_u32 v14, v13, 13, v14
    v_subrev_u32 v4, 2048, v14
    v_add_u32 v13, 6, v10
    v_and_b32 v14, 3, v13
    v_xor_b32 v14, v14, v11
    v_lshl_add_u32 v14, v14, 6, v12
    v_lshl_add_u32 v14, v13, 13, v14
    v_subrev_u32 v5, 3072, v14
    v_lshrrev_b32 v10, 3, v0
    v_mul_u32_u24 v10, 1152, v10
    v_bfe_u32 v11, v0, 1, 2
    v_lshrrev_b32 v12, 4, v0
    v_xor_b32 v11, v11, v12
    v_lshl_add_u32 v10, v11, 5, v10
    v_and_b32 v11, 1, v0
    v_lshl_add_u32 v10, v11, 4, v10
    v_add_u32 v6, 0, v10
    v_add_u32 v7, 8192, v10
    v_add_u32 v8, 16384, v10
    v_add_u32 v9, 24576, v10
    s_mul_i32 s56, s60, 8208
    s_add_u32 s56, s56, 57344
    s_add_u32 s61, s56, 32832
    s_add_u32 s57, s56, 65664
    s_lshl_b32 s62, s60, 17
    s_lshr_b32 s59, s2, 5
    s_bfe_u32 s63, s2, 0x20003
    s_mul_i32 s63, s63, 2
    s_add_u32 s59, s59, s63
    s_sub_u32 s63, s59, 9
    s_cselect_b32 s59, s59, s63
    s_mov_b32 s64, s62
    s_add_u32 s65, s62, 4718592
    s_lshl_b32 s59, s59, 19
    s_add_u32 s62, s62, s59
    s_mov_b32 s48, 18
L_wq:
    s_mov_b32 m0, s61
    s_add_u32 s63, s62, 65536
    buffer_load_dwordx4 v2, s[36:39], s62 offen offset:0 lds
    buffer_load_dwordx4 v3, s[36:39], s62 offen offset:1024 lds
    buffer_load_dwordx4 v4, s[36:39], s62 offen offset:2048 lds
    buffer_load_dwordx4 v5, s[36:39], s62 offen offset:3072 lds
    s_add_u32 m0, s61, 4104
    s_add_u32 s61, s61, 16416
    buffer_load_dwordx4 v2, s[36:39], s63 offen offset:0 lds
    buffer_load_dwordx4 v3, s[36:39], s63 offen offset:1024 lds
    buffer_load_dwordx4 v4, s[36:39], s63 offen offset:2048 lds
    buffer_load_dwordx4 v5, s[36:39], s63 offen offset:3072 lds
    s_add_u32 s62, s62, 262144
    s_cmp_eq_u32 s61, s57
    s_cselect_b32 s61, s56, s61
    s_cmp_eq_u32 s62, s65
    s_cselect_b32 s62, s64, s62
    s_sub_u32 s48, s48, 1
    s_cmp_gt_u32 s48, 15
    s_cbranch_scc1 L_wq
    s_waitcnt vmcnt(16)
    s_barrier
    s_cmp_gt_u32 s48, 0
    s_cbranch_scc1 L_wq
    s_waitcnt vmcnt(8)
    s_barrier
    s_waitcnt vmcnt(0)
    s_barrier
    s_barrier
    s_lshl_b32 s56, s60, 14
    s_mul_i32 s62, s60, 147456
    s_movk_i32 s58, 0
    s_lshr_b32 s57, s2, 5
    s_lshl_b32 s57, s57, 1
    s_add_u32 s57, s57, s60
    s_lshl_b32 s57, s57, 13
    v_lshlrev_b32 v20, 7, v0
    s_barrier
    s_barrier
    s_barrier
    s_barrier
    s_barrier
    s_barrier
    s_barrier
    s_barrier
    s_barrier
    s_barrier
    buffer_load_dword v32, v20, s[40:43], s57 offen
    s_add_u32 s57, s57, 131072
    buffer_load_dword v33, v20, s[40:43], s57 offen
    s_add_u32 s57, s57, 131072
    s_barrier
    buffer_load_dword v34, v20, s[40:43], s57 offen
    s_add_u32 s57, s57, 131072
    s_barrier
    s_barrier
    s_barrier
    s_add_u32 s61, s56, 131072
    s_add_u32 m0, s61, 0
    s_add_u32 s63, s62, 0
    buffer_load_dwordx4 v6, s[40:43], s63 offen offset:0 lds
    buffer_load_dwordx4 v7, s[40:43], s63 offen offset:1024 lds
    buffer_load_dwordx4 v8, s[40:43], s63 offen offset:2048 lds
    buffer_load_dwordx4 v9, s[40:43], s63 offen offset:3072 lds
    s_add_u32 m0, s61, 4096
    s_add_u32 s63, s62, 36864
    buffer_load_dwordx4 v6, s[40:43], s63 offen offset:0 lds
    buffer_load_dwordx4 v7, s[40:43], s63 offen offset:1024 lds
    buffer_load_dwordx4 v8, s[40:43], s63 offen offset:2048 lds
    buffer_load_dwordx4 v9, s[40:43], s63 offen offset:3072 lds
    s_add_u32 m0, s61, 8192
    s_add_u32 s63, s62, 73728
    buffer_load_dwordx4 v6, s[40:43], s63 offen offset:0 lds
    buffer_load_dwordx4 v7, s[40:43], s63 offen offset:1024 lds
    buffer_load_dwordx4 v8, s[40:43], s63 offen offset:2048 lds
    buffer_load_dwordx4 v9, s[40:43], s63 offen offset:3072 lds
    s_add_u32 m0, s61, 12288
    s_add_u32 s63, s62, 110592
    buffer_load_dwordx4 v6, s[40:43], s63 offen offset:0 lds
    buffer_load_dwordx4 v7, s[40:43], s63 offen offset:1024 lds
    buffer_load_dwordx4 v8, s[40:43], s63 offen offset:2048 lds
    buffer_load_dwordx4 v9, s[40:43], s63 offen offset:3072 lds
    s_add_u32 s62, s62, 128
    s_barrier
    s_waitcnt vmcnt(0)
    s_barrier
    s_add_u32 s61, s56, 0
    s_add_u32 m0, s61, 0
    s_add_u32 s63, s62, 0
    buffer_load_dwordx4 v6, s[40:43], s63 offen offset:0 lds
    buffer_load_dwordx4 v7, s[40:43], s63 offen offset:1024 lds
    buffer_load_dwordx4 v8, s[40:43], s63 offen offset:2048 lds
    buffer_load_dwordx4 v9, s[40:43], s63 offen offset:3072 lds
    s_add_u32 m0, s61, 4096
    s_add_u32 s63, s62, 36864
    buffer_load_dwordx4 v6, s[40:43], s63 offen offset:0 lds
    buffer_load_dwordx4 v7, s[40:43], s63 offen offset:1024 lds
    buffer_load_dwordx4 v8, s[40:43], s63 offen offset:2048 lds
    buffer_load_dwordx4 v9, s[40:43], s63 offen offset:3072 lds
    s_add_u32 m0, s61, 8192
    s_add_u32 s63, s62, 73728
    buffer_load_dwordx4 v6, s[40:43], s63 offen offset:0 lds
    buffer_load_dwordx4 v7, s[40:43], s63 offen offset:1024 lds
    buffer_load_dwordx4 v8, s[40:43], s63 offen offset:2048 lds
    buffer_load_dwordx4 v9, s[40:43], s63 offen offset:3072 lds
    s_add_u32 m0, s61, 12288
    s_add_u32 s63, s62, 110592
    buffer_load_dwordx4 v6, s[40:43], s63 offen offset:0 lds
    buffer_load_dwordx4 v7, s[40:43], s63 offen offset:1024 lds
    buffer_load_dwordx4 v8, s[40:43], s63 offen offset:2048 lds
    buffer_load_dwordx4 v9, s[40:43], s63 offen offset:3072 lds
    s_add_u32 s62, s62, 128
    s_barrier
    s_add_u32 s61, s56, 98304
    s_add_u32 m0, s61, 0
    s_add_u32 s63, s62, 0
    buffer_load_dwordx4 v6, s[40:43], s63 offen offset:0 lds
    buffer_load_dwordx4 v7, s[40:43], s63 offen offset:1024 lds
    buffer_load_dwordx4 v8, s[40:43], s63 offen offset:2048 lds
    buffer_load_dwordx4 v9, s[40:43], s63 offen offset:3072 lds
    s_add_u32 m0, s61, 4096
    s_add_u32 s63, s62, 36864
    buffer_load_dwordx4 v6, s[40:43], s63 offen offset:0 lds
    buffer_load_dwordx4 v7, s[40:43], s63 offen offset:1024 lds
    buffer_load_dwordx4 v8, s[40:43], s63 offen offset:2048 lds
    buffer_load_dwordx4 v9, s[40:43], s63 offen offset:3072 lds
    s_add_u32 m0, s61, 8192
    s_add_u32 s63, s62, 73728
    buffer_load_dwordx4 v6, s[40:43], s63 offen offset:0 lds
    buffer_load_dwordx4 v7, s[40:43], s63 offen offset:1024 lds
    buffer_load_dwordx4 v8, s[40:43], s63 offen offset:2048 lds
    buffer_load_dwordx4 v9, s[40:43], s63 offen offset:3072 lds
    s_add_u32 m0, s61, 12288
    s_add_u32 s63, s62, 110592
    buffer_load_dwordx4 v6, s[40:43], s63 offen offset:0 lds
    buffer_load_dwordx4 v7, s[40:43], s63 offen offset:1024 lds
    buffer_load_dwordx4 v8, s[40:43], s63 offen offset:2048 lds
    buffer_load_dwordx4 v9, s[40:43], s63 offen offset:3072 lds
    s_add_u32 s62, s62, 128
    s_mov_b32 s48, 6
    s_mov_b32 s58, 131072
L_wo:
    s_waitcnt vmcnt(16)
    s_barrier
    s_add_u32 s61, s56, s58
    s_add_u32 s58, s58, 32768
    s_cmp_eq_u32 s58, 32768
    s_cselect_b32 s58, 98304, s58
    s_cmp_eq_u32 s58, 163840
    s_cselect_b32 s58, 0, s58
    s_add_u32 m0, s61, 0
    s_add_u32 s63, s62, 0
    buffer_load_dwordx4 v6, s[40:43], s63 offen offset:0 lds
    buffer_load_dwordx4 v7, s[40:43], s63 offen offset:1024 lds
    buffer_load_dwordx4 v8, s[40:43], s63 offen offset:2048 lds
    buffer_load_dwordx4 v9, s[40:43], s63 offen offset:3072 lds
    s_add_u32 m0, s61, 4096
    s_add_u32 s63, s62, 36864
    buffer_load_dwordx4 v6, s[40:43], s63 offen offset:0 lds
    buffer_load_dwordx4 v7, s[40:43], s63 offen offset:1024 lds
    buffer_load_dwordx4 v8, s[40:43], s63 offen offset:2048 lds
    buffer_load_dwordx4 v9, s[40:43], s63 offen offset:3072 lds
    s_add_u32 m0, s61, 8192
    s_add_u32 s63, s62, 73728
    buffer_load_dwordx4 v6, s[40:43], s63 offen offset:0 lds
    buffer_load_dwordx4 v7, s[40:43], s63 offen offset:1024 lds
    buffer_load_dwordx4 v8, s[40:43], s63 offen offset:2048 lds
    buffer_load_dwordx4 v9, s[40:43], s63 offen offset:3072 lds
    s_add_u32 m0, s61, 12288
    s_add_u32 s63, s62, 110592
    buffer_load_dwordx4 v6, s[40:43], s63 offen offset:0 lds
    buffer_load_dwordx4 v7, s[40:43], s63 offen offset:1024 lds
    buffer_load_dwordx4 v8, s[40:43], s63 offen offset:2048 lds
    buffer_load_dwordx4 v9, s[40:43], s63 offen offset:3072 lds
    s_add_u32 s62, s62, 128
    s_sub_u32 s48, s48, 1
    s_cmp_gt_u32 s48, 0
    s_cbranch_scc1 L_wo
    s_waitcnt vmcnt(16)
    s_barrier
    s_waitcnt vmcnt(0)
    s_barrier
    s_branch L_red
L_ldx:
    v_lshrrev_b32 v10, 3, v0
    v_mul_u32_u24 v10, 1152, v10
    v_and_b32 v11, 7, v0
    v_lshrrev_b32 v12, 4, v0
    v_xor_b32 v13, 0, v12
    v_xor_b32 v13, v13, v11
    v_lshl_add_u32 v13, v13, 4, v10
    v_add_u32 v2, 0, v13
    v_xor_b32 v13, 4, v12
    v_xor_b32 v13, v13, v11
    v_lshl_add_u32 v13, v13, 4, v10
    v_add_u32 v3, 8192, v13
    v_xor_b32 v13, 0, v12
    v_xor_b32 v13, v13, v11
    v_lshl_add_u32 v13, v13, 4, v10
    v_add_u32 v4, 16384, v13
    v_xor_b32 v13, 4, v12
    v_xor_b32 v13, v13, v11
    v_lshl_add_u32 v13, v13, 4, v10
    v_add_u32 v5, 24576, v13
    s_mov_b32 s61, 123008
    s_lshr_b32 s62, s2, 5
    s_bfe_u32 s63, s2, 0x20003
    s_mul_i32 s63, s63, 2
    s_add_u32 s62, s62, s63
    s_sub_u32 s63, s62, 9
    s_cselect_b32 s62, s62, s63
    s_lshl_b32 s62, s62, 7
    s_mov_b32 s48, 9
L_x:
    s_add_u32 m0, s61, 0
    s_add_u32 s63, s62, 0
    buffer_load_dwordx4 v2, s[24:27], s63 offen offset:0 lds
    buffer_load_dwordx4 v3, s[24:27], s63 offen offset:1024 lds
    buffer_load_dwordx4 v4, s[24:27], s63 offen offset:2048 lds
    buffer_load_dwordx4 v5, s[24:27], s63 offen offset:3072 lds
    s_add_u32 m0, s61, 4096
    s_add_u32 s63, s62, 36864
    buffer_load_dwordx4 v2, s[24:27], s63 offen offset:0 lds
    buffer_load_dwordx4 v3, s[24:27], s63 offen offset:1024 lds
    buffer_load_dwordx4 v4, s[24:27], s63 offen offset:2048 lds
    buffer_load_dwordx4 v5, s[24:27], s63 offen offset:3072 lds
    s_add_u32 m0, s61, 8192
    s_add_u32 s63, s62, 73728
    buffer_load_dwordx4 v2, s[24:27], s63 offen offset:0 lds
    buffer_load_dwordx4 v3, s[24:27], s63 offen offset:1024 lds
    buffer_load_dwordx4 v4, s[24:27], s63 offen offset:2048 lds
    buffer_load_dwordx4 v5, s[24:27], s63 offen offset:3072 lds
    s_add_u32 s62, s62, 128
    s_add_u32 s61, s61, 12288
    s_cmp_eq_u32 s61, 159872
    s_cselect_b32 s61, 123008, s61
    s_cmp_eq_u32 s62, 1152
    s_cselect_b32 s62, 0, s62
    s_sub_u32 s48, s48, 1
    s_cmp_gt_u32 s48, 6
    s_cbranch_scc1 L_x
    s_cmp_lt_u32 s48, 6
    s_cbranch_scc1 L_x1
    s_waitcnt vmcnt(24)
    s_barrier
L_x1:
    s_barrier
    s_waitcnt vmcnt(12)
    s_barrier
    s_cmp_gt_u32 s48, 0
    s_cbranch_scc1 L_x
    v_lshrrev_b32 v10, 4, v0
    v_and_b32 v11, 15, v0
    v_lshlrev_b32 v13, 8, v10
    v_add_u32 v12, 0, v10
    v_lshlrev_b32 v12, 1, v12
    v_xor_b32 v12, v12, v11
    v_lshl_add_u32 v6, v12, 4, v13
    v_add_u32 v12, 4, v10
    v_lshlrev_b32 v12, 1, v12
    v_xor_b32 v12, v12, v11
    v_lshl_add_u32 v7, v12, 4, v13
    s_mov_b32 s60, 3
    s_barrier
    s_and_b32 s56, s60, 7
    s_lshl_b32 s56, s56, 14
    s_add_u32 s56, s56, 8192
    s_add_u32 s57, s60, s23
    s_and_b32 s57, s57, 15
    s_mov_b32 m0, s56
    s_lshl_b32 s57, s57, 13
    buffer_load_dwordx4 v6, s[32:35], s57 offen offset:0 nt lds
    buffer_load_dwordx4 v7, s[32:35], s57 offen offset:1024 nt lds
    buffer_load_dwordx4 v6, s[32:35], s57 offen offset:2048 nt lds
    buffer_load_dwordx4 v7, s[32:35], s57 offen offset:3072 nt lds
    s_add_u32 m0, s56, 4096
    s_add_u32 s57, s57, 4096
    buffer_load_dwordx4 v6, s[32:35], s57 offen offset:0 nt lds
    buffer_load_dwordx4 v7, s[32:35], s57 offen offset:1024 nt lds
    buffer_load_dwordx4 v6, s[32:35], s57 offen offset:2048 nt lds
    buffer_load_dwordx4 v7, s[32:35], s57 offen offset:3072 nt lds
    s_add_u32 s60, s60, 1
    s_waitcnt vmcnt(8)
    s_barrier
    s_and_b32 s56, s60, 7
    s_lshl_b32 s56, s56, 14
    s_add_u32 s56, s56, 8192
    s_add_u32 s57, s60, s23
    s_and_b32 s57, s57, 15
    s_mov_b32 m0, s56
    s_lshl_b32 s57, s57, 13
    buffer_load_dwordx4 v6, s[32:35], s57 offen offset:0 nt lds
    buffer_load_dwordx4 v7, s[32:35], s57 offen offset:1024 nt lds
    buffer_load_dwordx4 v6, s[32:35], s57 offen offset:2048 nt lds
    buffer_load_dwordx4 v7, s[32:35], s57 offen offset:3072 nt lds
    s_add_u32 m0, s56, 4096
    s_add_u32 s57, s57, 4096
    buffer_load_dwordx4 v6, s[32:35], s57 offen offset:0 nt lds
    buffer_load_dwordx4 v7, s[32:35], s57 offen offset:1024 nt lds
    buffer_load_dwordx4 v6, s[32:35], s57 offen offset:2048 nt lds
    buffer_load_dwordx4 v7, s[32:35], s57 offen offset:3072 nt lds
    s_add_u32 s60, s60, 1
    s_barrier
    s_and_b32 s56, s60, 7
    s_lshl_b32 s56, s56, 14
    s_add_u32 s56, s56, 8192
    s_add_u32 s57, s60, s23
    s_and_b32 s57, s57, 15
    s_mov_b32 m0, s56
    s_lshl_b32 s57, s57, 13
    buffer_load_dwordx4 v6, s[32:35], s57 offen offset:0 nt lds
    buffer_load_dwordx4 v7, s[32:35], s57 offen offset:1024 nt lds
    buffer_load_dwordx4 v6, s[32:35], s57 offen offset:2048 nt lds
    buffer_load_dwordx4 v7, s[32:35], s57 offen offset:3072 nt lds
    s_add_u32 m0, s56, 4096
    s_add_u32 s57, s57, 4096
    buffer_load_dwordx4 v6, s[32:35], s57 offen offset:0 nt lds
    buffer_load_dwordx4 v7, s[32:35], s57 offen offset:1024 nt lds
    buffer_load_dwordx4 v6, s[32:35], s57 offen offset:2048 nt lds
    buffer_load_dwordx4 v7, s[32:35], s57 offen offset:3072 nt lds
    s_add_u32 s60, s60, 1
    s_barrier
    s_barrier
    s_and_b32 s56, s60, 7
    s_lshl_b32 s56, s56, 14
    s_add_u32 s56, s56, 8192
    s_add_u32 s57, s60, s23
    s_and_b32 s57, s57, 15
    s_mov_b32 m0, s56
    s_lshl_b32 s57, s57, 13
    buffer_load_dwordx4 v6, s[32:35], s57 offen offset:0 nt lds
    buffer_load_dwordx4 v7, s[32:35], s57 offen offset:1024 nt lds
    buffer_load_dwordx4 v6, s[32:35], s57 offen offset:2048 nt lds
    buffer_load_dwordx4 v7, s[32:35], s57 offen offset:3072 nt lds
    s_add_u32 m0, s56, 4096
    s_add_u32 s57, s57, 4096
    buffer_load_dwordx4 v6, s[32:35], s57 offen offset:0 nt lds
    buffer_load_dwordx4 v7, s[32:35], s57 offen offset:1024 nt lds
    buffer_load_dwordx4 v6, s[32:35], s57 offen offset:2048 nt lds
    buffer_load_dwordx4 v7, s[32:35], s57 offen offset:3072 nt lds
    s_add_u32 s60, s60, 1
    s_barrier
    s_and_b32 s56, s60, 7
    s_lshl_b32 s56, s56, 14
    s_add_u32 s56, s56, 8192
    s_add_u32 s57, s60, s23
    s_and_b32 s57, s57, 15
    s_mov_b32 m0, s56
    s_lshl_b32 s57, s57, 13
    buffer_load_dwordx4 v6, s[32:35], s57 offen offset:0 nt lds
    buffer_load_dwordx4 v7, s[32:35], s57 offen offset:1024 nt lds
    buffer_load_dwordx4 v6, s[32:35], s57 offen offset:2048 nt lds
    buffer_load_dwordx4 v7, s[32:35], s57 offen offset:3072 nt lds
    s_add_u32 m0, s56, 4096
    s_add_u32 s57, s57, 4096
    buffer_load_dwordx4 v6, s[32:35], s57 offen offset:0 nt lds
    buffer_load_dwordx4 v7, s[32:35], s57 offen offset:1024 nt lds
    buffer_load_dwordx4 v6, s[32:35], s57 offen offset:2048 nt lds
    buffer_load_dwordx4 v7, s[32:35], s57 offen offset:3072 nt lds
    s_add_u32 s60, s60, 1
    s_barrier
    s_mov_b32 s61, 8
L_v:
    s_and_b32 s56, s60, 7
    s_lshl_b32 s56, s56, 14
    s_add_u32 s56, s56, 8192
    s_add_u32 s57, s60, s23
    s_and_b32 s57, s57, 15
    s_mov_b32 m0, s56
    s_lshl_b32 s57, s57, 13
    buffer_load_dwordx4 v6, s[32:35], s57 offen offset:0 nt lds
    buffer_load_dwordx4 v7, s[32:35], s57 offen offset:1024 nt lds
    buffer_load_dwordx4 v6, s[32:35], s57 offen offset:2048 nt lds
    buffer_load_dwordx4 v7, s[32:35], s57 offen offset:3072 nt lds
    s_add_u32 m0, s56, 4096
    s_add_u32 s57, s57, 4096
    buffer_load_dwordx4 v6, s[32:35], s57 offen offset:0 nt lds
    buffer_load_dwordx4 v7, s[32:35], s57 offen offset:1024 nt lds
    buffer_load_dwordx4 v6, s[32:35], s57 offen offset:2048 nt lds
    buffer_load_dwordx4 v7, s[32:35], s57 offen offset:3072 nt lds
    s_add_u32 s60, s60, 1
    s_waitcnt vmcnt(40)
    s_barrier
    s_sub_u32 s61, s61, 1
    s_cmp_gt_u32 s61, 0
    s_cbranch_scc1 L_v
    s_waitcnt vmcnt(32)
    s_barrier
    s_waitcnt vmcnt(24)
    s_barrier
    s_waitcnt vmcnt(16)
    s_barrier
    s_waitcnt vmcnt(8)
    s_barrier
    s_waitcnt vmcnt(0)
    s_barrier
    s_barrier
    s_barrier
    s_barrier
    s_barrier
    s_barrier
    s_barrier
    s_barrier
    s_barrier
    s_barrier
    s_branch L_red
L_ldk:
    v_mov_b32 v50, 0
    v_mov_b32 v49, 0
    v_mov_b32 v48, 0
    buffer_load_dword v51, v50, s[28:31], 0 offen
    buffer_load_dword v52, v50, s[32:35], 0 offen
    buffer_load_dword v53, v50, s[40:43], 0 offen
    buffer_load_dword v54, v50, s[44:47], 0 offen sc1
    s_mul_i32 s50, s21, 2048
    s_add_u32 s50, s50, 31457280
    s_add_u32 s68, s18, s50
    s_addc_u32 s69, s19, 0
    s_mov_b32 s70, 128
    s_mov_b32 s71, 0x20000
    s_mov_b32 s64, s16
    s_mov_b32 s65, s17
    s_mov_b32 s66, 256
    s_mov_b32 s67, 0x20000
    s_lshl_b32 s93, s21, 4
    s_lshl_b32 s50, s22, 3
    v_mov_b32 v46, s50
    v_mov_b32 v47, 1
    s_mov_b64 exec, 1
    buffer_store_dwordx2 v[48:49], v46, s[68:71], 0 offen sc1
    s_mov_b64 exec, -1
    v_lshrrev_b32 v10, 4, v0
    v_and_b32 v11, 15, v0
    v_lshlrev_b32 v13, 8, v10
    v_add_u32 v12, 0, v10
    v_xor_b32 v12, v12, v11
    v_lshl_add_u32 v2, v12, 4, v13
    v_add_u32 v12, 4, v10
    v_xor_b32 v12, v12, v11
    v_lshl_add_u32 v3, v12, 4, v13
    v_add_u32 v12, 8, v10
    v_xor_b32 v12, v12, v11
    v_lshl_add_u32 v4, v12, 4, v13
    v_add_u32 v12, 12, v10
    v_xor_b32 v12, v12, v11
    v_lshl_add_u32 v5, v12, 4, v13
    v_lshrrev_b32 v10, 4, v0
    v_and_b32 v11, 15, v0
    v_lshlrev_b32 v13, 8, v10
    v_add_u32 v12, 0, v10
    v_lshlrev_b32 v12, 1, v12
    v_xor_b32 v12, v12, v11
    v_lshl_add_u32 v6, v12, 4, v13
    v_add_u32 v12, 4, v10
    v_lshlrev_b32 v12, 1, v12
    v_xor_b32 v12, v12, v11
    v_lshl_add_u32 v7, v12, 4, v13
    s_mov_b32 s60, 0
    s_mov_b32 s61, 0
    s_lshr_b32 s62, s2, 3
    s_and_b32 s62, s62, 3
    s_mul_i32 s62, s62, 3
    s_add_u32 s62, s62, 2
    s_mov_b32 s63, -1
    s_branch L_ein
L_e:
    s_barrier
L_ein:
    s_sub_u32 s59, s63, s62
    s_cmp_lg_u32 s59, 0
    s_cbranch_scc1 L_e0
    s_waitcnt vmcnt(0)
    s_mov_b64 exec, 1
    buffer_atomic_add v47, v50, s[64:67], s93 offen sc1
    s_mov_b64 exec, -1
    s_and_b32 s56, s60, 7
    s_lshl_b32 s56, s56, 14
    s_add_u32 s57, s60, s23
    s_and_b32 s57, s57, 15
    s_mov_b32 m0, s56
    s_lshl_b32 s57, s57, 13
    buffer_load_dwordx4 v2, s[28:31], s57 offen offset:0 nt lds
    buffer_load_dwordx4 v3, s[28:31], s57 offen offset:1024 nt lds
    buffer_load_dwordx4 v4, s[28:31], s57 offen offset:2048 nt lds
    buffer_load_dwordx4 v5, s[28:31], s57 offen offset:3072 nt lds
    s_add_u32 m0, s56, 4096
    s_add_u32 s57, s57, 4096
    buffer_load_dwordx4 v2, s[28:31], s57 offen offset:0 nt lds
    buffer_load_dwordx4 v3, s[28:31], s57 offen offset:1024 nt lds
    buffer_load_dwordx4 v4, s[28:31], s57 offen offset:2048 nt lds
    buffer_load_dwordx4 v5, s[28:31], s57 offen offset:3072 nt lds
    s_add_u32 s60, s60, 1
    s_and_b32 s56, s61, 7
    s_lshl_b32 s56, s56, 14
    s_add_u32 s56, s56, 8192
    s_add_u32 s57, s61, s23
    s_and_b32 s57, s57, 15
    s_mov_b32 m0, s56
    s_lshl_b32 s57, s57, 13
    buffer_load_dwordx4 v6, s[32:35], s57 offen offset:0 nt lds
    buffer_load_dwordx4 v7, s[32:35], s57 offen offset:1024 nt lds
    buffer_load_dwordx4 v6, s[32:35], s57 offen offset:2048 nt lds
    buffer_load_dwordx4 v7, s[32:35], s57 offen offset:3072 nt lds
    s_add_u32 m0, s56, 4096
    s_add_u32 s57, s57, 4096
    buffer_load_dwordx4 v6, s[32:35], s57 offen offset:0 nt lds
    buffer_load_dwordx4 v7, s[32:35], s57 offen offset:1024 nt lds
    buffer_load_dwordx4 v6, s[32:35], s57 offen offset:2048 nt lds
    buffer_load_dwordx4 v7, s[32:35], s57 offen offset:3072 nt lds
    s_add_u32 s61, s61, 1
    s_and_b32 s56, s60, 7
    s_lshl_b32 s56, s56, 14
    s_add_u32 s57, s60, s23
    s_and_b32 s57, s57, 15
    s_mov_b32 m0, s56
    s_lshl_b32 s57, s57, 13
    buffer_load_dwordx4 v2, s[28:31], s57 offen offset:0 nt lds
    buffer_load_dwordx4 v3, s[28:31], s57 offen offset:1024 nt lds
    buffer_load_dwordx4 v4, s[28:31], s57 offen offset:2048 nt lds
    buffer_load_dwordx4 v5, s[28:31], s57 offen offset:3072 nt lds
    s_add_u32 m0, s56, 4096
    s_add_u32 s57, s57, 4096
    buffer_load_dwordx4 v2, s[28:31], s57 offen offset:0 nt lds
    buffer_load_dwordx4 v3, s[28:31], s57 offen offset:1024 nt lds
    buffer_load_dwordx4 v4, s[28:31], s57 offen offset:2048 nt lds
    buffer_load_dwordx4 v5, s[28:31], s57 offen offset:3072 nt lds
    s_add_u32 s60, s60, 1
    s_and_b32 s56, s61, 7
    s_lshl_b32 s56, s56, 14
    s_add_u32 s56, s56, 8192
    s_add_u32 s57, s61, s23
    s_and_b32 s57, s57, 15
    s_mov_b32 m0, s56
    s_lshl_b32 s57, s57, 13
    buffer_load_dwordx4 v6, s[32:35], s57 offen offset:0 nt lds
    buffer_load_dwordx4 v7, s[32:35], s57 offen offset:1024 nt lds
    buffer_load_dwordx4 v6, s[32:35], s57 offen offset:2048 nt lds
    buffer_load_dwordx4 v7, s[32:35], s57 offen offset:3072 nt lds
    s_add_u32 m0, s56, 4096
    s_add_u32 s57, s57, 4096
    buffer_load_dwordx4 v6, s[32:35], s57 offen offset:0 nt lds
    buffer_load_dwordx4 v7, s[32:35], s57 offen offset:1024 nt lds
    buffer_load_dwordx4 v6, s[32:35], s57 offen offset:2048 nt lds
    buffer_load_dwordx4 v7, s[32:35], s57 offen offset:3072 nt lds
    s_add_u32 s61, s61, 1
    s_and_b32 s56, s60, 7
    s_lshl_b32 s56, s56, 14
    s_add_u32 s57, s60, s23
    s_and_b32 s57, s57, 15
    s_mov_b32 m0, s56
    s_lshl_b32 s57, s57, 13
    buffer_load_dwordx4 v2, s[28:31], s57 offen offset:0 nt lds
    buffer_load_dwordx4 v3, s[28:31], s57 offen offset:1024 nt lds
    buffer_load_dwordx4 v4, s[28:31], s57 offen offset:2048 nt lds
    buffer_load_dwordx4 v5, s[28:31], s57 offen offset:3072 nt lds
    s_add_u32 m0, s56, 4096
    s_add_u32 s57, s57, 4096
    buffer_load_dwordx4 v2, s[28:31], s57 offen offset:0 nt lds
    buffer_load_dwordx4 v3, s[28:31], s57 offen offset:1024 nt lds
    buffer_load_dwordx4 v4, s[28:31], s57 offen offset:2048 nt lds
    buffer_load_dwordx4 v5, s[28:31], s57 offen offset:3072 nt lds
    s_add_u32 s60, s60, 1
    s_waitcnt vmcnt(40)
    s_and_b32 s56, s61, 7
    s_lshl_b32 s56, s56, 14
    s_add_u32 s56, s56, 8192
    s_add_u32 s57, s61, s23
    s_and_b32 s57, s57, 15
    s_mov_b32 m0, s56
    s_lshl_b32 s57, s57, 13
    buffer_load_dwordx4 v6, s[32:35], s57 offen offset:0 nt lds
    buffer_load_dwordx4 v7, s[32:35], s57 offen offset:1024 nt lds
    buffer_load_dwordx4 v6, s[32:35], s57 offen offset:2048 nt lds
    buffer_load_dwordx4 v7, s[32:35], s57 offen offset:3072 nt lds
    s_add_u32 m0, s56, 4096
    s_add_u32 s57, s57, 4096
    buffer_load_dwordx4 v6, s[32:35], s57 offen offset:0 nt lds
    buffer_load_dwordx4 v7, s[32:35], s57 offen offset:1024 nt lds
    buffer_load_dwordx4 v6, s[32:35], s57 offen offset:2048 nt lds
    buffer_load_dwordx4 v7, s[32:35], s57 offen offset:3072 nt lds
    s_add_u32 s61, s61, 1
    s_waitcnt vmcnt(40)
    s_and_b32 s56, s60, 7
    s_lshl_b32 s56, s56, 14
    s_add_u32 s57, s60, s23
    s_and_b32 s57, s57, 15
    s_mov_b32 m0, s56
    s_lshl_b32 s57, s57, 13
    buffer_load_dwordx4 v2, s[28:31], s57 offen offset:0 nt lds
    buffer_load_dwordx4 v3, s[28:31], s57 offen offset:1024 nt lds
    buffer_load_dwordx4 v4, s[28:31], s57 offen offset:2048 nt lds
    buffer_load_dwordx4 v5, s[28:31], s57 offen offset:3072 nt lds
    s_add_u32 m0, s56, 4096
    s_add_u32 s57, s57, 4096
    buffer_load_dwordx4 v2, s[28:31], s57 offen offset:0 nt lds
    buffer_load_dwordx4 v3, s[28:31], s57 offen offset:1024 nt lds
    buffer_load_dwordx4 v4, s[28:31], s57 offen offset:2048 nt lds
    buffer_load_dwordx4 v5, s[28:31], s57 offen offset:3072 nt lds
    s_add_u32 s60, s60, 1
L_e0:
    s_add_u32 s63, s63, 1
    s_cmp_lt_u32 s63, 14
    s_cbranch_scc1 L_e
    s_barrier
    s_barrier
    s_waitcnt vmcnt(48)
    s_and_b32 s56, s60, 7
    s_lshl_b32 s56, s56, 14
    s_add_u32 s57, s60, s23
    s_and_b32 s57, s57, 15
    s_mov_b32 m0, s56
    s_lshl_b32 s57, s57, 13
    buffer_load_dwordx4 v2, s[28:31], s57 offen offset:0 nt lds
    buffer_load_dwordx4 v3, s[28:31], s57 offen offset:1024 nt lds
    buffer_load_dwordx4 v4, s[28:31], s57 offen offset:2048 nt lds
    buffer_load_dwordx4 v5, s[28:31], s57 offen offset:3072 nt lds
    s_add_u32 m0, s56, 4096
    s_add_u32 s57, s57, 4096
    buffer_load_dwordx4 v2, s[28:31], s57 offen offset:0 nt lds
    buffer_load_dwordx4 v3, s[28:31], s57 offen offset:1024 nt lds
    buffer_load_dwordx4 v4, s[28:31], s57 offen offset:2048 nt lds
    buffer_load_dwordx4 v5, s[28:31], s57 offen offset:3072 nt lds
    s_add_u32 s60, s60, 1
    s_barrier
    s_waitcnt vmcnt(48)
    s_and_b32 s56, s60, 7
    s_lshl_b32 s56, s56, 14
    s_add_u32 s57, s60, s23
    s_and_b32 s57, s57, 15
    s_mov_b32 m0, s56
    s_lshl_b32 s57, s57, 13
    buffer_load_dwordx4 v2, s[28:31], s57 offen offset:0 nt lds
    buffer_load_dwordx4 v3, s[28:31], s57 offen offset:1024 nt lds
    buffer_load_dwordx4 v4, s[28:31], s57 offen offset:2048 nt lds
    buffer_load_dwordx4 v5, s[28:31], s57 offen offset:3072 nt lds
    s_add_u32 m0, s56, 4096
    s_add_u32 s57, s57, 4096
    buffer_load_dwordx4 v2, s[28:31], s57 offen offset:0 nt lds
    buffer_load_dwordx4 v3, s[28:31], s57 offen offset:1024 nt lds
    buffer_load_dwordx4 v4, s[28:31], s57 offen offset:2048 nt lds
    buffer_load_dwordx4 v5, s[28:31], s57 offen offset:3072 nt lds
    s_add_u32 s60, s60, 1
    s_barrier
    s_waitcnt vmcnt(48)
    s_and_b32 s56, s60, 7
    s_lshl_b32 s56, s56, 14
    s_add_u32 s57, s60, s23
    s_and_b32 s57, s57, 15
    s_mov_b32 m0, s56
    s_lshl_b32 s57, s57, 13
    buffer_load_dwordx4 v2, s[28:31], s57 offen offset:0 nt lds
    buffer_load_dwordx4 v3, s[28:31], s57 offen offset:1024 nt lds
    buffer_load_dwordx4 v4, s[28:31], s57 offen offset:2048 nt lds
    buffer_load_dwordx4 v5, s[28:31], s57 offen offset:3072 nt lds
    s_add_u32 m0, s56, 4096
    s_add_u32 s57, s57, 4096
    buffer_load_dwordx4 v2, s[28:31], s57 offen offset:0 nt lds
    buffer_load_dwordx4 v3, s[28:31], s57 offen offset:1024 nt lds
    buffer_load_dwordx4 v4, s[28:31], s57 offen offset:2048 nt lds
    buffer_load_dwordx4 v5, s[28:31], s57 offen offset:3072 nt lds
    s_add_u32 s60, s60, 1
    s_waitcnt vmcnt(63)
    s_barrier
    s_waitcnt vmcnt(56)
    s_barrier
    s_waitcnt vmcnt(55)
    s_and_b32 s56, s60, 7
    s_lshl_b32 s56, s56, 14
    s_add_u32 s57, s60, s23
    s_and_b32 s57, s57, 15
    s_mov_b32 m0, s56
    s_lshl_b32 s57, s57, 13
    buffer_load_dwordx4 v2, s[28:31], s57 offen offset:0 nt lds
    buffer_load_dwordx4 v3, s[28:31], s57 offen offset:1024 nt lds
    buffer_load_dwordx4 v4, s[28:31], s57 offen offset:2048 nt lds
    buffer_load_dwordx4 v5, s[28:31], s57 offen offset:3072 nt lds
    s_add_u32 m0, s56, 4096
    s_add_u32 s57, s57, 4096
    buffer_load_dwordx4 v2, s[28:31], s57 offen offset:0 nt lds
    buffer_load_dwordx4 v3, s[28:31], s57 offen offset:1024 nt lds
    buffer_load_dwordx4 v4, s[28:31], s57 offen offset:2048 nt lds
    buffer_load_dwordx4 v5, s[28:31], s57 offen offset:3072 nt lds
    s_add_u32 s60, s60, 1
    s_waitcnt vmcnt(48)
    s_barrier
    s_mov_b32 s62, 8
L_k:
    s_and_b32 s56, s60, 7
    s_lshl_b32 s56, s56, 14
    s_add_u32 s57, s60, s23
    s_and_b32 s57, s57, 15
    s_mov_b32 m0, s56
    s_lshl_b32 s57, s57, 13
    buffer_load_dwordx4 v2, s[28:31], s57 offen offset:0 nt lds
    buffer_load_dwordx4 v3, s[28:31], s57 offen offset:1024 nt lds
    buffer_load_dwordx4 v4, s[28:31], s57 offen offset:2048 nt lds
    buffer_load_dwordx4 v5, s[28:31], s57 offen offset:3072 nt lds
    s_add_u32 m0, s56, 4096
    s_add_u32 s57, s57, 4096
    buffer_load_dwordx4 v2, s[28:31], s57 offen offset:0 nt lds
    buffer_load_dwordx4 v3, s[28:31], s57 offen offset:1024 nt lds
    buffer_load_dwordx4 v4, s[28:31], s57 offen offset:2048 nt lds
    buffer_load_dwordx4 v5, s[28:31], s57 offen offset:3072 nt lds
    s_add_u32 s60, s60, 1
    s_waitcnt vmcnt(40)
    s_barrier
    s_sub_u32 s62, s62, 1
    s_cmp_gt_u32 s62, 0
    s_cbranch_scc1 L_k
    s_waitcnt vmcnt(32)
    s_barrier
    s_waitcnt vmcnt(24)
    s_barrier
    s_waitcnt vmcnt(16)
    s_barrier
    s_waitcnt vmcnt(8)
    s_barrier
    s_waitcnt vmcnt(0)
    s_barrier
    s_waitcnt vmcnt(0)
    s_barrier
    s_barrier
    v_mov_b32 v22, v46
    v_mov_b32 v21, 1
    v_and_b32 v24, 15, v0
    v_lshlrev_b32 v24, 3, v24
    buffer_load_dword v20, v50, s[64:67], s93 offen sc1
    s_barrier
    s_mul_i32 s50, s21, 1769472
    s_add_u32 s72, s18, s50
    s_addc_u32 s73, s19, 0
    s_mov_b32 s74, 1769472
    s_mov_b32 s75, 0x20000
    s_mul_i32 s50, s21, 110592
    s_add_u32 s76, s14, s50
    s_addc_u32 s77, s15, 0
    s_mov_b32 s78, 110592
    s_mov_b32 s79, 0x20000
    v_lshrrev_b32 v100, 4, v0
    v_bfe_u32 v101, v0, 3, 1
    v_and_b32 v102, 7, v0
    v_mul_u32_u24 v103, 110592, v100
    v_lshl_add_u32 v103, v101, 9, v103
    v_lshl_add_u32 v103, v102, 4, v103
    v_mul_u32_u24 v104, 1152, v102
    v_lshl_add_u32 v104, v100, 5, v104
    v_lshl_add_u32 v104, v101, 4, v104
    v_and_b32 v105, 1, v0
    v_lshlrev_b32 v105, 4, v105
    v_mov_b32 v106, 0x3f80
    v_lshlrev_b32 v105, v105, v106
    v_bfe_u32 v106, v0, 1, 3
    v_lshlrev_b32 v106, v106, 1
    v_bfe_i32 v108, v106, 0, 1
    v_bfe_i32 v109, v106, 1, 1
    v_bfe_i32 v110, v106, 2, 1
    v_bfe_i32 v111, v106, 3, 1
    v_bfe_i32 v112, v106, 4, 1
    v_bfe_i32 v113, v106, 5, 1
    v_bfe_i32 v114, v106, 6, 1
    v_bfe_i32 v115, v106, 7, 1
    v_and_b32 v108, v108, v105
    v_and_b32 v109, v109, v105
    v_and_b32 v110, v110, v105
    v_and_b32 v111, v111, v105
    v_and_b32 v112, v112, v105
    v_and_b32 v113, v113, v105
    v_and_b32 v114, v114, v105
    v_and_b32 v115, v115, v105
    v_mov_b32 v107, 81920
    s_lshr_b32 s50, s20, 1
    s_lshl_b32 s50, s50, 3
    s_and_b32 s51, s20, 1
    s_add_u32 s50, s50, s51
    s_lshl_b32 s50, s50, 7
    s_add_u32 s50, s50, 82944
    v_lshlrev_b32 v99, 4, v102
    v_lshl_add_u32 v99, v101, 9, v99
    v_add_u32 v99, s50, v99
    s_lshl_b32 s50, s22, 4
    s_lshl_b64 s[94:95], 0xffff, s50
    s_not_b64 s[94:95], s[94:95]
    s_lshr_b32 s99, s22, 2
    s_cmp_lt_u32 s20, 6
    s_cselect_b32 s99, s99, 8
    ds_write_b64 v107, v[48:49]
    ds_write_b64 v107, v[48:49] offset:8
    s_waitcnt lgkmcnt(0)
    s_barrier
    s_barrier
    s_barrier
    s_barrier
    s_barrier
    s_barrier
    s_barrier
    s_branch L_poll
L_slow:
    s_waitcnt lgkmcnt(0)
    v_and_b32 v10, 15, v0
    v_lshrrev_b32 v11, 4, v0
    v_lshlrev_b32 v103, 4, v11
    v_lshl_add_u32 v103, v10, 8, v103
    v_lshlrev_b32 v104, 1, v10
    v_lshl_add_u32 v104, v11, 10, v104
    s_mov_b32 s52, 0
    s_mov_b32 s53, 4096
    s_nop 3
    v_mov_b32 v100, 0xff800000
    v_mov_b32 v101, 0xff800000
    v_mov_b32 v102, 0xff800000
    v_mov_b32 v112, 0
    v_mov_b32 v113, 0
    v_mov_b32 v114, 0
    v_mov_b32 v115, 0
    v_mov_b32 v116, 0
    v_mov_b32 v117, 0
    v_mov_b32 v118, 0
    v_mov_b32 v119, 0
    v_mov_b32 v120, 0
    v_mov_b32 v121, 0
    v_mov_b32 v122, 0
    v_mov_b32 v123, 0
    v_mov_b32 v124, 0
    v_mov_b32 v125, 0
    v_mov_b32 v126, 0
    v_mov_b32 v127, 0
    v_mov_b32 v128, 0
    v_mov_b32 v129, 0
    v_mov_b32 v130, 0
    v_mov_b32 v131, 0
    v_mov_b32 v132, 0
    v_mov_b32 v133, 0
    v_mov_b32 v134, 0
    v_mov_b32 v135, 0
    v_mov_b32 v136, 0
    v_mov_b32 v137, 0
    v_mov_b32 v138, 0
    v_mov_b32 v139, 0
    v_mov_b32 v140, 0
    v_mov_b32 v141, 0
    v_mov_b32 v142, 0
    v_mov_b32 v143, 0
    v_mov_b32 v144, 0
    v_mov_b32 v145, 0
    v_mov_b32 v146, 0
    v_mov_b32 v147, 0
    v_mov_b32 v148, 0
    v_mov_b32 v149, 0
    v_mov_b32 v150, 0
    v_mov_b32 v151, 0
    v_mov_b32 v152, 0
    v_mov_b32 v153, 0
    v_mov_b32 v154, 0
    v_mov_b32 v155, 0
    v_mov_b32 v156, 0
    v_mov_b32 v157, 0
    v_mov_b32 v158, 0
    v_mov_b32 v159, 0
    v_mov_b32 v160, 0
    v_mov_b32 v161, 0
    v_mov_b32 v162, 0
    v_mov_b32 v163, 0
    v_mov_b32 v164, 0
    v_mov_b32 v165, 0
    v_mov_b32 v166, 0
    v_mov_b32 v167, 0
    v_mov_b32 v168, 0
    v_mov_b32 v169, 0
    v_mov_b32 v170, 0
    v_mov_b32 v171, 0
    v_mov_b32 v172, 0
    v_mov_b32 v173, 0
    v_mov_b32 v174, 0
    v_mov_b32 v175, 0
    v_mov_b32 v176, 0
    v_mov_b32 v177, 0
    v_mov_b32 v178, 0
    v_mov_b32 v179, 0
    v_mov_b32 v180, 0
    v_mov_b32 v181, 0
    v_mov_b32 v182, 0
    v_mov_b32 v183, 0
    v_mov_b32 v184, 0
    v_mov_b32 v185, 0
    v_mov_b32 v186, 0
    v_mov_b32 v187, 0
    v_mov_b32 v188, 0
    v_mov_b32 v189, 0
    v_mov_b32 v190, 0
    v_mov_b32 v191, 0
    v_mov_b32 v192, 0
    v_mov_b32 v193, 0
    v_mov_b32 v194, 0
    v_mov_b32 v195, 0
    v_mov_b32 v196, 0
    v_mov_b32 v197, 0
    v_mov_b32 v198, 0
    v_mov_b32 v199, 0
    v_mov_b32 v200, 0
    v_mov_b32 v201, 0
    v_mov_b32 v202, 0
    v_mov_b32 v203, 0
    v_mov_b32 v204, 0
    v_mov_b32 v205, 0
    v_mov_b32 v206, 0
    v_mov_b32 v207, 0
    v_mov_b32 v84, 0
    v_mov_b32 v85, 0
    v_mov_b32 v86, 0
    v_mov_b32 v87, 0
    v_mov_b32 v88, 0
    v_mov_b32 v89, 0
    v_mov_b32 v90, 0
    v_mov_b32 v91, 0
    v_mov_b32 v92, 0
    v_mov_b32 v93, 0
    v_mov_b32 v94, 0
    v_mov_b32 v95, 0
L_s1:
    buffer_load_dwordx4 v[16:19], v103, s[28:31], s52 offen offset:0
    buffer_load_dwordx4 v[20:23], v103, s[28:31], s52 offen offset:64
    buffer_load_dwordx4 v[24:27], v103, s[28:31], s52 offen offset:128
    buffer_load_dwordx4 v[28:31], v103, s[28:31], s52 offen offset:192
    buffer_load_dwordx4 v[32:35], v103, s[28:31], s53 offen offset:0
    buffer_load_dwordx4 v[36:39], v103, s[28:31], s53 offen offset:64
    buffer_load_dwordx4 v[40:43], v103, s[28:31], s53 offen offset:128
    buffer_load_dwordx4 v[44:47], v103, s[28:31], s53 offen offset:192
    s_waitcnt vmcnt(0)
    v_mfma_f32_16x16x32_bf16 v[48:51], v[16:19], v[208:211], 0
    v_mfma_f32_16x16x32_bf16 v[52:55], v[16:19], v[212:215], 0
    v_mfma_f32_16x16x32_bf16 v[56:59], v[16:19], v[216:219], 0
    v_mfma_f32_16x16x32_bf16 v[48:51], v[20:23], v[220:223], v[48:51]
    v_mfma_f32_16x16x32_bf16 v[52:55], v[20:23], v[224:227], v[52:55]
    v_mfma_f32_16x16x32_bf16 v[56:59], v[20:23], v[228:231], v[56:59]
    v_mfma_f32_16x16x32_bf16 v[48:51], v[24:27], v[232:235], v[48:51]
    v_mfma_f32_16x16x32_bf16 v[52:55], v[24:27], v[236:239], v[52:55]
    v_mfma_f32_16x16x32_bf16 v[56:59], v[24:27], v[240:243], v[56:59]
    v_mfma_f32_16x16x32_bf16 v[48:51], v[28:31], v[244:247], v[48:51]
    v_mfma_f32_16x16x32_bf16 v[52:55], v[28:31], v[248:251], v[52:55]
    v_mfma_f32_16x16x32_bf16 v[56:59], v[28:31], v[252:255], v[56:59]
    v_mfma_f32_16x16x32_bf16 v[72:75], v[32:35], v[208:211], 0
    v_mfma_f32_16x16x32_bf16 v[76:79], v[32:35], v[212:215], 0
    v_mfma_f32_16x16x32_bf16 v[80:83], v[32:35], v[216:219], 0
    v_mfma_f32_16x16x32_bf16 v[72:75], v[36:39], v[220:223], v[72:75]
    v_mfma_f32_16x16x32_bf16 v[76:79], v[36:39], v[224:227], v[76:79]
    v_mfma_f32_16x16x32_bf16 v[80:83], v[36:39], v[228:231], v[80:83]
    v_mfma_f32_16x16x32_bf16 v[72:75], v[40:43], v[232:235], v[72:75]
    v_mfma_f32_16x16x32_bf16 v[76:79], v[40:43], v[236:239], v[76:79]
    v_mfma_f32_16x16x32_bf16 v[80:83], v[40:43], v[240:243], v[80:83]
    v_mfma_f32_16x16x32_bf16 v[72:75], v[44:47], v[244:247], v[72:75]
    v_mfma_f32_16x16x32_bf16 v[76:79], v[44:47], v[248:251], v[76:79]
    v_mfma_f32_16x16x32_bf16 v[80:83], v[44:47], v[252:255], v[80:83]
    s_nop 7
    v_max3_f32 v100, v48, v49, v100
    v_max3_f32 v100, v50, v51, v100
    v_max3_f32 v100, v72, v73, v100
    v_max3_f32 v100, v74, v75, v100
    v_max3_f32 v101, v52, v53, v101
    v_max3_f32 v101, v54, v55, v101
    v_max3_f32 v101, v76, v77, v101
    v_max3_f32 v101, v78, v79, v101
    v_max3_f32 v102, v56, v57, v102
    v_max3_f32 v102, v58, v59, v102
    v_max3_f32 v102, v80, v81, v102
    v_max3_f32 v102, v82, v83, v102
    s_add_u32 s52, s52, 8192
    s_add_u32 s53, s53, 8192
    s_cmp_lt_u32 s52, 131072
    s_cbranch_scc1 L_s1
    v_mov_b32 v60, v100
    v_mov_b32 v61, v101
    v_mov_b32 v62, v102
    s_nop 1
    v_permlane32_swap_b32 v60, v100
    v_permlane32_swap_b32 v61, v101
    v_permlane32_swap_b32 v62, v102
    s_nop 1
    v_max_f32 v100, v60, v100
    v_max_f32 v101, v61, v101
    v_max_f32 v102, v62, v102
    v_mov_b32 v60, v100
    v_mov_b32 v61, v101
    v_mov_b32 v62, v102
    s_nop 1
    v_permlane16_swap_b32 v60, v100
    v_permlane16_swap_b32 v61, v101
    v_permlane16_swap_b32 v62, v102
    s_nop 1
    v_max_f32 v100, v60, v100
    v_max_f32 v101, v61, v101
    v_max_f32 v102, v62, v102
    s_mov_b32 s52, 0
    s_mov_b32 s53, 4096
L_s2:
    buffer_load_dwordx4 v[16:19], v103, s[28:31], s52 offen offset:0
    buffer_load_dwordx4 v[20:23], v103, s[28:31], s52 offen offset:64
    buffer_load_dwordx4 v[24:27], v103, s[28:31], s52 offen offset:128
    buffer_load_dwordx4 v[28:31], v103, s[28:31], s52 offen offset:192
    buffer_load_dwordx4 v[32:35], v103, s[28:31], s53 offen offset:0
    buffer_load_dwordx4 v[36:39], v103, s[28:31], s53 offen offset:64
    buffer_load_dwordx4 v[40:43], v103, s[28:31], s53 offen offset:128
    buffer_load_dwordx4 v[44:47], v103, s[28:31], s53 offen offset:192
    s_waitcnt vmcnt(0)
    v_mfma_f32_16x16x32_bf16 v[48:51], v[16:19], v[208:211], 0
    v_mfma_f32_16x16x32_bf16 v[52:55], v[16:19], v[212:215], 0
    v_mfma_f32_16x16x32_bf16 v[56:59], v[16:19], v[216:219], 0
    v_mfma_f32_16x16x32_bf16 v[48:51], v[20:23], v[220:223], v[48:51]
    v_mfma_f32_16x16x32_bf16 v[52:55], v[20:23], v[224:227], v[52:55]
    v_mfma_f32_16x16x32_bf16 v[56:59], v[20:23], v[228:231], v[56:59]
    v_mfma_f32_16x16x32_bf16 v[48:51], v[24:27], v[232:235], v[48:51]
    v_mfma_f32_16x16x32_bf16 v[52:55], v[24:27], v[236:239], v[52:55]
    v_mfma_f32_16x16x32_bf16 v[56:59], v[24:27], v[240:243], v[56:59]
    v_mfma_f32_16x16x32_bf16 v[48:51], v[28:31], v[244:247], v[48:51]
    v_mfma_f32_16x16x32_bf16 v[52:55], v[28:31], v[248:251], v[52:55]
    v_mfma_f32_16x16x32_bf16 v[56:59], v[28:31], v[252:255], v[56:59]
    v_mfma_f32_16x16x32_bf16 v[72:75], v[32:35], v[208:211], 0
    v_mfma_f32_16x16x32_bf16 v[76:79], v[32:35], v[212:215], 0
    v_mfma_f32_16x16x32_bf16 v[80:83], v[32:35], v[216:219], 0
    v_mfma_f32_16x16x32_bf16 v[72:75], v[36:39], v[220:223], v[72:75]
    v_mfma_f32_16x16x32_bf16 v[76:79], v[36:39], v[224:227], v[76:79]
    v_mfma_f32_16x16x32_bf16 v[80:83], v[36:39], v[228:231], v[80:83]
    v_mfma_f32_16x16x32_bf16 v[72:75], v[40:43], v[232:235], v[72:75]
    v_mfma_f32_16x16x32_bf16 v[76:79], v[40:43], v[236:239], v[76:79]
    v_mfma_f32_16x16x32_bf16 v[80:83], v[40:43], v[240:243], v[80:83]
    v_mfma_f32_16x16x32_bf16 v[72:75], v[44:47], v[244:247], v[72:75]
    v_mfma_f32_16x16x32_bf16 v[76:79], v[44:47], v[248:251], v[76:79]
    v_mfma_f32_16x16x32_bf16 v[80:83], v[44:47], v[252:255], v[80:83]
    s_nop 7
    buffer_load_ushort v16, v104, s[32:35], s52 offen offset:0
    buffer_load_ushort v32, v104, s[32:35], s52 offen offset:256
    buffer_load_ushort v17, v104, s[32:35], s52 offen offset:512
    buffer_load_ushort v33, v104, s[32:35], s52 offen offset:768
    buffer_load_ushort v18, v104, s[32:35], s53 offen offset:0
    buffer_load_ushort v34, v104, s[32:35], s53 offen offset:256
    buffer_load_ushort v19, v104, s[32:35], s53 offen offset:512
    buffer_load_ushort v35, v104, s[32:35], s53 offen offset:768
    buffer_load_ushort v20, v104, s[32:35], s52 offen offset:32
    buffer_load_ushort v36, v104, s[32:35], s52 offen offset:288
    buffer_load_ushort v21, v104, s[32:35], s52 offen offset:544
    buffer_load_ushort v37, v104, s[32:35], s52 offen offset:800
    buffer_load_ushort v22, v104, s[32:35], s53 offen offset:32
    buffer_load_ushort v38, v104, s[32:35], s53 offen offset:288
    buffer_load_ushort v23, v104, s[32:35], s53 offen offset:544
    buffer_load_ushort v39, v104, s[32:35], s53 offen offset:800
    buffer_load_ushort v24, v104, s[32:35], s52 offen offset:64
    buffer_load_ushort v40, v104, s[32:35], s52 offen offset:320
    buffer_load_ushort v25, v104, s[32:35], s52 offen offset:576
    buffer_load_ushort v41, v104, s[32:35], s52 offen offset:832
    buffer_load_ushort v26, v104, s[32:35], s53 offen offset:64
    buffer_load_ushort v42, v104, s[32:35], s53 offen offset:320
    buffer_load_ushort v27, v104, s[32:35], s53 offen offset:576
    buffer_load_ushort v43, v104, s[32:35], s53 offen offset:832
    buffer_load_ushort v28, v104, s[32:35], s52 offen offset:96
    buffer_load_ushort v44, v104, s[32:35], s52 offen offset:352
    buffer_load_ushort v29, v104, s[32:35], s52 offen offset:608
    buffer_load_ushort v45, v104, s[32:35], s52 offen offset:864
    buffer_load_ushort v30, v104, s[32:35], s53 offen offset:96
    buffer_load_ushort v46, v104, s[32:35], s53 offen offset:352
    buffer_load_ushort v31, v104, s[32:35], s53 offen offset:608
    buffer_load_ushort v47, v104, s[32:35], s53 offen offset:864
    v_sub_f32 v48, v48, v100
    v_sub_f32 v49, v49, v100
    v_sub_f32 v50, v50, v100
    v_sub_f32 v51, v51, v100
    v_sub_f32 v72, v72, v100
    v_sub_f32 v73, v73, v100
    v_sub_f32 v74, v74, v100
    v_sub_f32 v75, v75, v100
    v_sub_f32 v52, v52, v101
    v_sub_f32 v53, v53, v101
    v_sub_f32 v54, v54, v101
    v_sub_f32 v55, v55, v101
    v_sub_f32 v76, v76, v101
    v_sub_f32 v77, v77, v101
    v_sub_f32 v78, v78, v101
    v_sub_f32 v79, v79, v101
    v_sub_f32 v56, v56, v102
    v_sub_f32 v57, v57, v102
    v_sub_f32 v58, v58, v102
    v_sub_f32 v59, v59, v102
    v_sub_f32 v80, v80, v102
    v_sub_f32 v81, v81, v102
    v_sub_f32 v82, v82, v102
    v_sub_f32 v83, v83, v102
    v_exp_f32 v48, v48
    v_exp_f32 v49, v49
    v_exp_f32 v50, v50
    v_exp_f32 v51, v51
    v_exp_f32 v52, v52
    v_exp_f32 v53, v53
    v_exp_f32 v54, v54
    v_exp_f32 v55, v55
    v_exp_f32 v56, v56
    v_exp_f32 v57, v57
    v_exp_f32 v58, v58
    v_exp_f32 v59, v59
    v_exp_f32 v72, v72
    v_exp_f32 v73, v73
    v_exp_f32 v74, v74
    v_exp_f32 v75, v75
    v_exp_f32 v76, v76
    v_exp_f32 v77, v77
    v_exp_f32 v78, v78
    v_exp_f32 v79, v79
    v_exp_f32 v80, v80
    v_exp_f32 v81, v81
    v_exp_f32 v82, v82
    v_exp_f32 v83, v83
    s_nop 0
    v_cvt_pk_bf16_f32 v60, v48, v49
    v_cvt_pk_bf16_f32 v61, v50, v51
    v_cvt_pk_bf16_f32 v62, v72, v73
    v_cvt_pk_bf16_f32 v63, v74, v75
    v_cvt_pk_bf16_f32 v64, v52, v53
    v_cvt_pk_bf16_f32 v65, v54, v55
    v_cvt_pk_bf16_f32 v66, v76, v77
    v_cvt_pk_bf16_f32 v67, v78, v79
    v_cvt_pk_bf16_f32 v68, v56, v57
    v_cvt_pk_bf16_f32 v69, v58, v59
    v_cvt_pk_bf16_f32 v70, v80, v81
    v_cvt_pk_bf16_f32 v71, v82, v83
    s_nop 1
    v_mfma_f32_16x16x32_bf16 v[84:87], v[96:99], v[60:63], v[84:87]
    v_mfma_f32_16x16x32_bf16 v[88:91], v[96:99], v[64:67], v[88:91]
    v_mfma_f32_16x16x32_bf16 v[92:95], v[96:99], v[68:71], v[92:95]
    s_waitcnt vmcnt(0)
    v_lshl_or_b32 v16, v32, 16, v16
    v_lshl_or_b32 v17, v33, 16, v17
    v_lshl_or_b32 v18, v34, 16, v18
    v_lshl_or_b32 v19, v35, 16, v19
    v_lshl_or_b32 v20, v36, 16, v20
    v_lshl_or_b32 v21, v37, 16, v21
    v_lshl_or_b32 v22, v38, 16, v22
    v_lshl_or_b32 v23, v39, 16, v23
    v_lshl_or_b32 v24, v40, 16, v24
    v_lshl_or_b32 v25, v41, 16, v25
    v_lshl_or_b32 v26, v42, 16, v26
    v_lshl_or_b32 v27, v43, 16, v27
    v_lshl_or_b32 v28, v44, 16, v28
    v_lshl_or_b32 v29, v45, 16, v29
    v_lshl_or_b32 v30, v46, 16, v30
    v_lshl_or_b32 v31, v47, 16, v31
    s_nop 1
    v_mfma_f32_16x16x32_bf16 v[112:115], v[16:19], v[60:63], v[112:115]
    v_mfma_f32_16x16x32_bf16 v[116:119], v[16:19], v[64:67], v[116:119]
    v_mfma_f32_16x16x32_bf16 v[120:123], v[16:19], v[68:71], v[120:123]
    v_mfma_f32_16x16x32_bf16 v[124:127], v[20:23], v[60:63], v[124:127]
    v_mfma_f32_16x16x32_bf16 v[128:131], v[20:23], v[64:67], v[128:131]
    v_mfma_f32_16x16x32_bf16 v[132:135], v[20:23], v[68:71], v[132:135]
    v_mfma_f32_16x16x32_bf16 v[136:139], v[24:27], v[60:63], v[136:139]
    v_mfma_f32_16x16x32_bf16 v[140:143], v[24:27], v[64:67], v[140:143]
    v_mfma_f32_16x16x32_bf16 v[144:147], v[24:27], v[68:71], v[144:147]
    v_mfma_f32_16x16x32_bf16 v[148:151], v[28:31], v[60:63], v[148:151]
    v_mfma_f32_16x16x32_bf16 v[152:155], v[28:31], v[64:67], v[152:155]
    v_mfma_f32_16x16x32_bf16 v[156:159], v[28:31], v[68:71], v[156:159]
    s_nop 7
    buffer_load_ushort v16, v104, s[32:35], s52 offen offset:128
    buffer_load_ushort v32, v104, s[32:35], s52 offen offset:384
    buffer_load_ushort v17, v104, s[32:35], s52 offen offset:640
    buffer_load_ushort v33, v104, s[32:35], s52 offen offset:896
    buffer_load_ushort v18, v104, s[32:35], s53 offen offset:128
    buffer_load_ushort v34, v104, s[32:35], s53 offen offset:384
    buffer_load_ushort v19, v104, s[32:35], s53 offen offset:640
    buffer_load_ushort v35, v104, s[32:35], s53 offen offset:896
    buffer_load_ushort v20, v104, s[32:35], s52 offen offset:160
    buffer_load_ushort v36, v104, s[32:35], s52 offen offset:416
    buffer_load_ushort v21, v104, s[32:35], s52 offen offset:672
    buffer_load_ushort v37, v104, s[32:35], s52 offen offset:928
    buffer_load_ushort v22, v104, s[32:35], s53 offen offset:160
    buffer_load_ushort v38, v104, s[32:35], s53 offen offset:416
    buffer_load_ushort v23, v104, s[32:35], s53 offen offset:672
    buffer_load_ushort v39, v104, s[32:35], s53 offen offset:928
    buffer_load_ushort v24, v104, s[32:35], s52 offen offset:192
    buffer_load_ushort v40, v104, s[32:35], s52 offen offset:448
    buffer_load_ushort v25, v104, s[32:35], s52 offen offset:704
    buffer_load_ushort v41, v104, s[32:35], s52 offen offset:960
    buffer_load_ushort v26, v104, s[32:35], s53 offen offset:192
    buffer_load_ushort v42, v104, s[32:35], s53 offen offset:448
    buffer_load_ushort v27, v104, s[32:35], s53 offen offset:704
    buffer_load_ushort v43, v104, s[32:35], s53 offen offset:960
    buffer_load_ushort v28, v104, s[32:35], s52 offen offset:224
    buffer_load_ushort v44, v104, s[32:35], s52 offen offset:480
    buffer_load_ushort v29, v104, s[32:35], s52 offen offset:736
    buffer_load_ushort v45, v104, s[32:35], s52 offen offset:992
    buffer_load_ushort v30, v104, s[32:35], s53 offen offset:224
    buffer_load_ushort v46, v104, s[32:35], s53 offen offset:480
    buffer_load_ushort v31, v104, s[32:35], s53 offen offset:736
    buffer_load_ushort v47, v104, s[32:35], s53 offen offset:992
    s_waitcnt vmcnt(0)
    v_lshl_or_b32 v16, v32, 16, v16
    v_lshl_or_b32 v17, v33, 16, v17
    v_lshl_or_b32 v18, v34, 16, v18
    v_lshl_or_b32 v19, v35, 16, v19
    v_lshl_or_b32 v20, v36, 16, v20
    v_lshl_or_b32 v21, v37, 16, v21
    v_lshl_or_b32 v22, v38, 16, v22
    v_lshl_or_b32 v23, v39, 16, v23
    v_lshl_or_b32 v24, v40, 16, v24
    v_lshl_or_b32 v25, v41, 16, v25
    v_lshl_or_b32 v26, v42, 16, v26
    v_lshl_or_b32 v27, v43, 16, v27
    v_lshl_or_b32 v28, v44, 16, v28
    v_lshl_or_b32 v29, v45, 16, v29
    v_lshl_or_b32 v30, v46, 16, v30
    v_lshl_or_b32 v31, v47, 16, v31
    s_nop 1
    v_mfma_f32_16x16x32_bf16 v[160:163], v[16:19], v[60:63], v[160:163]
    v_mfma_f32_16x16x32_bf16 v[164:167], v[16:19], v[64:67], v[164:167]
    v_mfma_f32_16x16x32_bf16 v[168:171], v[16:19], v[68:71], v[168:171]
    v_mfma_f32_16x16x32_bf16 v[172:175], v[20:23], v[60:63], v[172:175]
    v_mfma_f32_16x16x32_bf16 v[176:179], v[20:23], v[64:67], v[176:179]
    v_mfma_f32_16x16x32_bf16 v[180:183], v[20:23], v[68:71], v[180:183]
    v_mfma_f32_16x16x32_bf16 v[184:187], v[24:27], v[60:63], v[184:187]
    v_mfma_f32_16x16x32_bf16 v[188:191], v[24:27], v[64:67], v[188:191]
    v_mfma_f32_16x16x32_bf16 v[192:195], v[24:27], v[68:71], v[192:195]
    v_mfma_f32_16x16x32_bf16 v[196:199], v[28:31], v[60:63], v[196:199]
    v_mfma_f32_16x16x32_bf16 v[200:203], v[28:31], v[64:67], v[200:203]
    v_mfma_f32_16x16x32_bf16 v[204:207], v[28:31], v[68:71], v[204:207]
    s_nop 7
    s_add_u32 s52, s52, 8192
    s_add_u32 s53, s53, 8192
    s_cmp_lt_u32 s52, 131072
    s_cbranch_scc1 L_s2
    v_mov_b32 v16, 0
    v_mov_b32 v17, 0
    v_mov_b32 v18, 0
    v_mov_b32 v19, 0
    v_mov_b32 v20, 0
    v_mov_b32 v21, 0
    v_mov_b32 v22, 0
    v_mov_b32 v23, 0
    v_mov_b32 v24, 0
    v_mov_b32 v25, 0
    v_mov_b32 v26, 0
    v_mov_b32 v27, 0
    v_mov_b32 v28, 0
    v_mov_b32 v29, 0
    v_mov_b32 v30, 0
    v_mov_b32 v31, 0
    v_mov_b32 v32, 0
    v_mov_b32 v33, 0
    v_mov_b32 v34, 0
    v_mov_b32 v35, 0
    v_mov_b32 v36, 0
    v_mov_b32 v37, 0
    v_mov_b32 v38, 0
    v_mov_b32 v39, 0
    v_mov_b32 v40, 0
    v_mov_b32 v41, 0
    v_mov_b32 v42, 0
    v_mov_b32 v43, 0
    v_mov_b32 v44, 0
    v_mov_b32 v45, 0
    v_mov_b32 v46, 0
    v_mov_b32 v47, 0
    v_mov_b32 v60, 0
    v_mov_b32 v61, 0
    v_mov_b32 v62, 0
    v_mov_b32 v63, 0
    v_mov_b32 v64, 0
    v_mov_b32 v65, 0
    v_mov_b32 v66, 0
    v_mov_b32 v67, 0
    v_mov_b32 v68, 0
    v_mov_b32 v69, 0
    v_mov_b32 v70, 0
    v_mov_b32 v71, 0
    s_branch L_norm
L_end:
    s_endpgm
.section .rodata,"a"
.p2align 6
.amdhsa_kernel standalone__gqa_block_cached__near_ridge_kernel
  .amdhsa_next_free_vgpr 256
  .amdhsa_next_free_sgpr 102
  .amdhsa_accum_offset 256
  .amdhsa_group_segment_fixed_size 0
  .amdhsa_kernarg_size 64
  .amdhsa_user_sgpr_count 2
  .amdhsa_user_sgpr_kernarg_segment_ptr 1
  .amdhsa_system_sgpr_workgroup_id_x 1
.end_amdhsa_kernel
```
